```python
import torch

def _softmax(x, axis=-1):
    return torch.softmax(x, dim=axis)
def _gelu(x):
    return torch.nn.functional.gelu(x, approximate="tanh")
def _silu(x):
    return torch.nn.functional.silu(x)
def _sigmoid(x):
    return torch.sigmoid(x)
def _layernorm(x, axis=-1, eps=1e-5):
    m = x.mean(dim=axis, keepdim=True)
    v = x.var(dim=axis, keepdim=True, unbiased=False)
    return (x - m) / torch.sqrt(v + eps)
def _scatter_add(tgt, idx, src, axis=0):
    return tgt.clone().index_add_(axis, idx, src)
def _segment_sum(src, seg, n):
    out = torch.zeros((n,) + src.shape[1:], dtype=src.dtype)
    return out.index_add_(0, seg, src)
def _pad(x, pw):
    flat = tuple(v for pair in reversed(pw) for v in pair)
    return torch.nn.functional.pad(x, flat)

kernel_name = 'concat_heads__gqa_block_cached__compressed_kv_cla__decode'

def setup_inputs():

    _w = (lambda a: (lambda t: t.to(torch.bfloat16) if t.is_floating_point() else t)(torch.as_tensor(a)))
    def _A_setup():
        B, Sq, D = 4, 1, 576
        Hq, Hkv, Sk, Dh = 32, 16, 4096, 128
        assert Hq % Hkv == 0, (Hq, Hkv)
        return {
            "x": _w((lambda *s: torch.randn(*s, dtype=torch.bfloat16) * 1.6)(B, Sq, D)),
            "k_cache": _w((lambda *s: torch.randn(*s, dtype=torch.bfloat16) * 1.6)(B, Hkv, Sk, Dh)),
            "v_cache": _w((lambda *s: torch.randn(*s, dtype=torch.bfloat16) * 0.05)(B, Hkv, Sk, Dh)),
            "wq": _w((lambda *s: torch.randn(*s, dtype=torch.bfloat16) * 1.6)(D, Hq * Dh) * (D ** -0.5)),
            "wo": _w((lambda *s: torch.randn(*s, dtype=torch.bfloat16) * 0.05)(Hq * Dh, D) * ((Hq * Dh) ** -0.5)),
        }
    _A_in = _A_setup()

    def _B_setup():
        B, H, Sq, Sk, D, M = 4, 32, 1, 4096, 128, 576
        Dc = 4 * D
        return {
            "x": _w((lambda *s: torch.randn(*s, dtype=torch.bfloat16) * 3.2)(B, Sq, M)),
            "c_kv": _w((lambda *s: torch.randn(*s, dtype=torch.bfloat16) * 0.1)(B, Sk, Dc)),
            "w_q": _w((lambda *s: torch.randn(*s, dtype=torch.bfloat16) * 6.4)(M, H, D) * (M ** -0.5)),
            "w_uk": _w((lambda *s: torch.randn(*s, dtype=torch.bfloat16) * 6.4)(Dc, H, D) * (Dc ** -0.5)),
            "w_uv": _w((lambda *s: torch.randn(*s, dtype=torch.bfloat16) * 0.1)(Dc, H, D) * (Dc ** -0.5)),
            "w_o": _w((lambda *s: torch.randn(*s, dtype=torch.bfloat16) * 0.1)(H, D, M) * ((H * D) ** -0.5)),
        }
    _B_in = _B_setup()

    return {
        "A_x": _A_in["x"],
        "A_k_cache": _A_in["k_cache"],
        "A_v_cache": _A_in["v_cache"],
        "A_wq": _A_in["wq"],
        "A_wo": _A_in["wo"],
        "B_x": _B_in["x"],
        "B_c_kv": _B_in["c_kv"],
        "B_w_q": _B_in["w_q"],
        "B_w_uk": _B_in["w_uk"],
        "B_w_uv": _B_in["w_uv"],
        "B_w_o": _B_in["w_o"],
    }

def reference(A_x, A_k_cache, A_v_cache, A_wq, A_wo, B_x, B_c_kv, B_w_q, B_w_uk, B_w_uv, B_w_o):
    def _A_ref(x, k_cache, v_cache, wq, wo):
        B, Sq, D = x.shape
        Hq, Dh = 32, 128
        Hkv = k_cache.shape[1]
        rep = Hq // Hkv
        q = (lambda x, *d: x.permute(*d))((x @ wq).reshape(B, Sq, Hq, Dh), 0, 2, 1, 3)
        k = (lambda x, n, axis: torch.repeat_interleave(x, n, dim=axis))(k_cache, rep, axis=1)
        v = (lambda x, n, axis: torch.repeat_interleave(x, n, dim=axis))(v_cache, rep, axis=1)
        scores = torch.einsum("bhqd,bhkd->bhqk", q, k) * (Dh ** -0.5)
        p = _softmax(scores, axis=-1)
        o = torch.einsum("bhqk,bhkd->bhqd", p, v)
        return (lambda x, *d: x.permute(*d))(o, 0, 2, 1, 3).reshape(B, Sq, Hq * Dh) @ wo

    def _B_ref(x, c_kv, w_q, w_uk, w_uv, w_o):
        B, Sq, M = x.shape[0], x.shape[1], x.shape[2]
        Sk = c_kv.shape[1]
        H, D = w_q.shape[1], w_q.shape[2]
        q = torch.einsum("bqm,mhd->bhqd", x, w_q)
        k = torch.einsum("bkc,chd->bhkd", c_kv, w_uk)
        v = torch.einsum("bkc,chd->bhkd", c_kv, w_uv)
        scores = torch.einsum("bhqd,bhkd->bhqk", q, k) * (D ** -0.5)
        off = Sk - Sq
        qi = torch.arange(Sq)[:, None]
        kj = torch.arange(Sk)[None, :]
        cmask = kj <= (qi + off)
        scores = torch.where(cmask[None, None], scores, -1e9)
        p = _softmax(scores, axis=-1)
        ctx = torch.einsum("bhqk,bhkd->bhqd", p, v)
        return torch.einsum("bhqd,hdm->bqm", ctx, w_o)

    a = _A_ref(A_x, A_k_cache, A_v_cache, A_wq, A_wo)
    b = _B_ref(B_x, B_c_kv, B_w_q, B_w_uk, B_w_uv, B_w_o)
    return torch.concatenate([a, b], axis=-1)
```

```asm
; @launch grid=(256,1,1) block=(512,1,1) lds=163840
.amdgcn_target "amdgcn-amd-amdhsa--gfx950"
.text
.globl concat_heads__gqa_block_cached__compressed_kv_cla__decode_kernel
.p2align 8
.type concat_heads__gqa_block_cached__compressed_kv_cla__decode_kernel,@function
concat_heads__gqa_block_cached__compressed_kv_cla__decode_kernel:
    s_cmp_ge_u32 s2, 256
    s_cbranch_scc1 L_end
    s_load_dwordx16 s[64:79], s[0:1], 0
    s_load_dwordx8 s[80:87], s[0:1], 64
    s_load_dwordx4 s[88:91], s[0:1], 96
    v_lshrrev_b32 v1, 6, v0
    v_and_b32 v0, 63, v0
    v_readfirstlane_b32 s3, v1
    v_lshlrev_b32 v1, 2, v0
    v_add_u32 v1, 151616, v1
    v_mov_b32 v2, 0
    s_mov_b64 exec, 0xffff
    ds_write_b32 v1, v2
    s_mov_b64 exec, -1
    s_lshr_b32 s28, s2, 5
    s_lshl_b32 s29, s28, 2
    s_lshr_b32 s46, 0x13220030, s29
    s_and_b32 s46, s46, 15
    s_lshr_b32 s45, 810876928, s29
    s_and_b32 s45, s45, 15
    s_add_u32 s45, s45, s2
    s_and_b32 s45, s45, 31
    s_lshr_b32 s29, 0x22, s28
    s_and_b32 s29, s29, 1
    s_lshl_b32 s29, s29, 5
    s_add_u32 s45, s45, s29
    s_lshr_b32 s28, s2, 6
    s_cmp_lg_u32 s28, 1
    s_cbranch_scc1 L_id2_2
    s_lshr_b32 s45, s2, 1
    s_and_b32 s46, s2, 1
L_id2_2:
    s_lshl_b32 s47, s45, 2
    s_add_u32 s47, s47, s46
    v_lshrrev_b32 v1, 4, v0
    v_and_b32 v2, 15, v0
    v_lshlrev_b32 v4, 4, v0
    s_waitcnt lgkmcnt(0)
    s_mov_b32 s4, s90
    s_mov_b32 s5, s91
    s_mov_b32 s6, 268435456
    s_mov_b32 s7, 0x20000
    s_cmp_lg_u32 s3, 4
    s_cbranch_scc1 L_clrd_3
    s_setprio 3
    s_load_dword s63, s[90:91], 0
    v_mov_b32 v8, -1
    v_mov_b32 v9, -1
    v_mov_b32 v10, -1
    v_mov_b32 v11, -1
    s_lshl_b32 s30, s47, 10
    s_add_u32 s30, s30, 65536
    s_lshr_b32 s31, s2, 5
    s_cmp_eq_u32 s31, 6
    s_cselect_b32 s31, 0, -1
    s_cselect_b32 s32, 4286578687, -1
    v_mov_b32 v12, s31
    v_mov_b32 v13, s31
    v_mov_b32 v14, s31
    v_mov_b32 v15, s31
    s_mov_b32 exec_lo, 0
    v_mov_b32 v12, s32
    v_mov_b32 v14, s32
    s_mov_b32 exec_lo, -1
    s_mov_b32 exec_hi, 0xffffff
    buffer_store_dwordx4 v[12:15], v4, s[4:7], s30 offen sc1
    s_mov_b64 exec, -1
    s_cmp_ge_u32 s2, 128
    s_cbranch_scc1 L_clr1_4
    s_lshl_b32 s31, s2, 10
    s_add_u32 s31, s31, 327680
    s_mov_b32 s32, 1
    s_branch L_clrl_6
L_clr1_4:
    s_cmp_ge_u32 s2, 192
    s_cbranch_scc1 L_clr2_5
    s_cmp_ge_u32 s2, 160
    s_cbranch_scc1 L_clrd_3
    s_sub_u32 s31, s2, 128
    s_lshl_b32 s31, s31, 12
    s_add_u32 s31, s31, 458752
    s_mov_b32 s32, 4
    s_branch L_clrl_6
L_clr2_5:
    s_and_b32 s31, s2, 31
    s_mul_i32 s31, s31, 9216
    s_add_u32 s31, s31, 884736
    s_cmp_ge_u32 s2, 224
    s_cselect_b32 s32, 294912, 0
    s_sub_u32 s31, s31, s32
    s_mov_b32 s32, 9
L_clrl_6:
    buffer_store_dwordx4 v[8:11], v4, s[4:7], s31 offen sc1
    s_add_u32 s31, s31, 1024
    s_sub_u32 s32, s32, 1
    s_cmp_lg_u32 s32, 0
    s_cbranch_scc1 L_clrl_6
L_clrd_3:
    s_barrier
    s_cmp_ge_u32 s3, 4
    s_cbranch_scc1 L_awave
    s_setprio 2
    s_cmp_ge_u32 s2, 224
    s_cbranch_scc1 L_at
    s_cmp_ge_u32 s2, 192
    s_cbranch_scc1 L_bh2
    s_cmp_ge_u32 s2, 128
    s_cbranch_scc1 L_bh1
    s_cmp_lt_u32 s2, 64
    s_cselect_b32 s12, s78, s70
    s_cselect_b32 s13, s79, s71
    s_mov_b32 s14, 4718592
    s_mov_b32 s15, 0x20000
    s_cselect_b32 s16, s74, s64
    s_cselect_b32 s17, s75, s65
    s_mov_b32 s18, 4608
    s_mov_b32 s19, 0x20000
    s_and_b32 s34, s2, 63
    s_lshl_b32 s34, s34, 7
    s_mul_i32 s35, s3, 1179648
    s_add_u32 s34, s34, s35
    s_mul_i32 s35, s3, 18432
    s_add_u32 s35, s35, 73728
    v_lshlrev_b32 v5, 1, v1
    v_and_b32 v6, 7, v0
    v_xor_b32 v5, v5, v6
    v_lshlrev_b32 v5, 4, v5
    v_lshrrev_b32 v6, 3, v0
    v_lshl_add_u32 v5, v6, 13, v5
    s_mov_b32 m0, 152704
    v_and_b32 v6, 3, v2
    buffer_load_dwordx4 v4, s[16:19], 0 offen lds
    buffer_load_dwordx4 v4, s[16:19], 0 offen offset:1024 lds
    buffer_load_dwordx4 v4, s[16:19], 0 offen offset:2048 lds
    buffer_load_dwordx4 v4, s[16:19], 0 offen offset:3072 lds
    s_mov_b32 m0, 156800
    s_mov_b32 s38, 4096
    buffer_load_dwordx4 v4, s[16:19], s38 offen lds
    s_mov_b32 m0, s35
    s_waitcnt vmcnt(59)
    buffer_load_dwordx4 v5, s[12:15], s34 offen offset:0 nt lds
    s_add_u32 s34, s34, 65536
    s_add_u32 s35, s35, 1024
    s_mov_b32 m0, s35
    s_waitcnt vmcnt(59)
    buffer_load_dwordx4 v5, s[12:15], s34 offen offset:0 nt lds
    s_add_u32 s34, s34, 65536
    s_add_u32 s35, s35, 1024
    s_mov_b32 m0, s35
    s_waitcnt vmcnt(59)
    buffer_load_dwordx4 v5, s[12:15], s34 offen offset:0 nt lds
    s_add_u32 s34, s34, 65536
    s_add_u32 s35, s35, 1024
    s_mov_b32 m0, s35
    s_waitcnt vmcnt(59)
    buffer_load_dwordx4 v5, s[12:15], s34 offen offset:0 nt lds
    s_add_u32 s34, s34, 65536
    s_add_u32 s35, s35, 1024
    s_mov_b32 m0, s35
    s_waitcnt vmcnt(59)
    buffer_load_dwordx4 v5, s[12:15], s34 offen offset:0 nt lds
    s_add_u32 s34, s34, 65536
    s_add_u32 s35, s35, 1024
    s_mov_b32 m0, s35
    s_waitcnt vmcnt(59)
    buffer_load_dwordx4 v5, s[12:15], s34 offen offset:0 nt lds
    s_add_u32 s34, s34, 65536
    s_add_u32 s35, s35, 1024
    s_mov_b32 m0, s35
    s_waitcnt vmcnt(59)
    buffer_load_dwordx4 v5, s[12:15], s34 offen offset:0 nt lds
    s_add_u32 s34, s34, 65536
    s_add_u32 s35, s35, 1024
    s_mov_b32 m0, s35
    s_waitcnt vmcnt(59)
    buffer_load_dwordx4 v5, s[12:15], s34 offen offset:0 nt lds
    s_add_u32 s34, s34, 65536
    s_add_u32 s35, s35, 1024
    s_mov_b32 m0, s35
    s_waitcnt vmcnt(59)
    buffer_load_dwordx4 v5, s[12:15], s34 offen offset:0 nt lds
    s_add_u32 s34, s34, 65536
    s_add_u32 s35, s35, 1024
    s_mov_b32 m0, s35
    s_waitcnt vmcnt(59)
    buffer_load_dwordx4 v5, s[12:15], s34 offen offset:0 nt lds
    s_add_u32 s34, s34, 65536
    s_add_u32 s35, s35, 1024
    s_mov_b32 m0, s35
    s_waitcnt vmcnt(59)
    buffer_load_dwordx4 v5, s[12:15], s34 offen offset:0 nt lds
    s_add_u32 s34, s34, 65536
    s_add_u32 s35, s35, 1024
    s_mov_b32 m0, s35
    s_waitcnt vmcnt(59)
    buffer_load_dwordx4 v5, s[12:15], s34 offen offset:0 nt lds
    s_add_u32 s34, s34, 65536
    s_add_u32 s35, s35, 1024
    s_mov_b32 m0, s35
    s_waitcnt vmcnt(59)
    buffer_load_dwordx4 v5, s[12:15], s34 offen offset:0 nt lds
    s_add_u32 s34, s34, 65536
    s_add_u32 s35, s35, 1024
    s_mov_b32 m0, s35
    s_waitcnt vmcnt(59)
    buffer_load_dwordx4 v5, s[12:15], s34 offen offset:0 nt lds
    s_add_u32 s34, s34, 65536
    s_add_u32 s35, s35, 1024
    s_mov_b32 m0, s35
    s_waitcnt vmcnt(59)
    buffer_load_dwordx4 v5, s[12:15], s34 offen offset:0 nt lds
    s_add_u32 s34, s34, 65536
    s_add_u32 s35, s35, 1024
    s_mov_b32 m0, s35
    s_waitcnt vmcnt(59)
    buffer_load_dwordx4 v5, s[12:15], s34 offen offset:0 nt lds
    s_add_u32 s34, s34, 65536
    s_add_u32 s35, s35, 1024
    s_mov_b32 m0, s35
    s_waitcnt vmcnt(59)
    buffer_load_dwordx4 v5, s[12:15], s34 offen offset:0 nt lds
    s_add_u32 s34, s34, 65536
    s_add_u32 s35, s35, 1024
    s_mov_b32 m0, s35
    s_waitcnt vmcnt(59)
    buffer_load_dwordx4 v5, s[12:15], s34 offen offset:0 nt lds
    v_mul_u32_u24 v6, 1152, v6
    v_lshl_add_u32 v6, v1, 3, v6
    v_add_u32 v6, 152704, v6
    s_waitcnt vmcnt(18)
    ds_read2_b64 v[64:67], v6 offset0:0 offset1:4
    ds_read2_b64 v[68:71], v6 offset0:8 offset1:12
    ds_read2_b64 v[72:75], v6 offset0:16 offset1:20
    ds_read2_b64 v[76:79], v6 offset0:24 offset1:28
    ds_read2_b64 v[80:83], v6 offset0:32 offset1:36
    ds_read2_b64 v[84:87], v6 offset0:40 offset1:44
    ds_read2_b64 v[88:91], v6 offset0:48 offset1:52
    ds_read2_b64 v[92:95], v6 offset0:56 offset1:60
    ds_read2_b64 v[96:99], v6 offset0:64 offset1:68
    ds_read2_b64 v[100:103], v6 offset0:72 offset1:76
    ds_read2_b64 v[104:107], v6 offset0:80 offset1:84
    ds_read2_b64 v[108:111], v6 offset0:88 offset1:92
    ds_read2_b64 v[112:115], v6 offset0:96 offset1:100
    s_waitcnt lgkmcnt(8)
    ds_read2_b64 v[116:119], v6 offset0:104 offset1:108
    ds_read2_b64 v[120:123], v6 offset0:112 offset1:116
    ds_read2_b64 v[124:127], v6 offset0:120 offset1:124
    ds_read2_b64 v[128:131], v6 offset0:128 offset1:132
    ds_read2_b64 v[132:135], v6 offset0:136 offset1:140
    v_lshrrev_b32 v7, 2, v0
    v_bfe_u32 v8, v0, 3, 2
    v_xor_b32 v8, s3, v8
    v_lshlrev_b32 v8, 5, v8
    v_lshl_add_u32 v8, v7, 7, v8
    v_and_b32 v7, 3, v0
    v_lshl_add_u32 v8, v7, 3, v8
    v_add_u32 v8, 73728, v8
    v_add_u32 v9, 0x8000, v8
    v_and_b32 v6, 3, v2
    v_lshlrev_b32 v6, 7, v6
    v_lshl_add_u32 v6, v1, 3, v6
    s_lshl_b32 s38, s3, 5
    s_add_u32 s38, s38, 151680
    v_add_u32 v6, s38, v6
    v_mov_b32 v16, 151664
    s_mov_b32 s29, 1600000
L_wl_7:
    ds_read_b32 v17, v16
    s_sub_u32 s29, s29, 1
    s_cbranch_scc1 L_wl_7_x
    s_waitcnt lgkmcnt(0)
    v_readfirstlane_b32 s28, v17
    s_cmp_ge_u32 s28, 1
    s_nop 2
    s_cbranch_scc1 L_wl_7_x
    s_sleep 1
    s_branch L_wl_7
L_wl_7_x:
    s_waitcnt lgkmcnt(0)
    ds_read_b32 v17, v16 offset:4
    s_waitcnt lgkmcnt(0)
    v_readfirstlane_b32 s63, v17
    s_waitcnt vmcnt(8)
    s_cmp_lg_u32 s3, 0
    s_nop 1
    s_cbranch_scc1 L_gate_8
    v_mov_b32 v16, 151656
    v_mov_b32 v17, 4
    ds_write_b32 v16, v17
L_gate_8:
    s_waitcnt vmcnt(0)
    s_waitcnt lgkmcnt(0)
    v_mov_b32 v16, 151616
    v_mov_b32 v17, 1
    s_mov_b64 exec, 1
    ds_add_u32 v16, v17
    s_mov_b64 exec, -1
    v_mov_b32 v16, 151616
    s_mov_b32 s29, 1600000
L_wl_9:
    ds_read_b32 v17, v16
    s_sub_u32 s29, s29, 1
    s_cbranch_scc1 L_wl_9_x
    s_waitcnt lgkmcnt(0)
    v_readfirstlane_b32 s28, v17
    s_cmp_ge_u32 s28, 4
    s_nop 2
    s_cbranch_scc1 L_wl_9_x
    s_branch L_wl_9
L_wl_9_x:
    s_waitcnt lgkmcnt(0)
    ds_read_b64_tr_b16 v[140:141], v8 offset:0
    ds_read_b64_tr_b16 v[142:143], v8 offset:2048
    ds_read_b64_tr_b16 v[144:145], v8 offset:4096
    ds_read_b64_tr_b16 v[146:147], v8 offset:6144
    ds_read_b64_tr_b16 v[148:149], v8 offset:8192
    ds_read_b64_tr_b16 v[150:151], v8 offset:10240
    ds_read_b64_tr_b16 v[152:153], v8 offset:12288
    ds_read_b64_tr_b16 v[154:155], v8 offset:14336
    ds_read_b64_tr_b16 v[156:157], v8 offset:16384
    ds_read_b64_tr_b16 v[158:159], v8 offset:18432
    ds_read_b64_tr_b16 v[160:161], v8 offset:20480
    ds_read_b64_tr_b16 v[162:163], v8 offset:22528
    ds_read_b64_tr_b16 v[164:165], v8 offset:24576
    ds_read_b64_tr_b16 v[166:167], v8 offset:26624
    s_waitcnt lgkmcnt(12)
    v_mfma_f32_16x16x32_bf16 v[40:43], v[140:143], v[64:67], 0
    ds_read_b64_tr_b16 v[168:169], v8 offset:28672
    ds_read_b64_tr_b16 v[170:171], v8 offset:30720
    s_waitcnt lgkmcnt(12)
    v_mfma_f32_16x16x32_bf16 v[44:47], v[144:147], v[68:71], 0
    ds_read_b64_tr_b16 v[140:141], v9 offset:0
    ds_read_b64_tr_b16 v[142:143], v9 offset:2048
    s_waitcnt lgkmcnt(12)
    v_mfma_f32_16x16x32_bf16 v[40:43], v[148:151], v[72:75], v[40:43]
    ds_read_b64_tr_b16 v[144:145], v9 offset:4096
    ds_read_b64_tr_b16 v[146:147], v9 offset:6144
    s_waitcnt lgkmcnt(12)
    v_mfma_f32_16x16x32_bf16 v[44:47], v[152:155], v[76:79], v[44:47]
    ds_read_b64_tr_b16 v[148:149], v9 offset:8192
    ds_read_b64_tr_b16 v[150:151], v9 offset:10240
    s_waitcnt lgkmcnt(12)
    v_mfma_f32_16x16x32_bf16 v[40:43], v[156:159], v[80:83], v[40:43]
    ds_read_b64_tr_b16 v[152:153], v9 offset:12288
    ds_read_b64_tr_b16 v[154:155], v9 offset:14336
    s_waitcnt lgkmcnt(12)
    v_mfma_f32_16x16x32_bf16 v[44:47], v[160:163], v[84:87], v[44:47]
    ds_read_b64_tr_b16 v[156:157], v9 offset:16384
    ds_read_b64_tr_b16 v[158:159], v9 offset:18432
    s_waitcnt lgkmcnt(12)
    v_mfma_f32_16x16x32_bf16 v[40:43], v[164:167], v[88:91], v[40:43]
    ds_read_b64_tr_b16 v[160:161], v9 offset:20480
    ds_read_b64_tr_b16 v[162:163], v9 offset:22528
    s_waitcnt lgkmcnt(12)
    v_mfma_f32_16x16x32_bf16 v[44:47], v[168:171], v[92:95], v[44:47]
    ds_read_b64_tr_b16 v[164:165], v9 offset:24576
    ds_read_b64_tr_b16 v[166:167], v9 offset:26624
    s_waitcnt lgkmcnt(12)
    v_mfma_f32_16x16x32_bf16 v[40:43], v[140:143], v[96:99], v[40:43]
    ds_read_b64_tr_b16 v[168:169], v9 offset:28672
    ds_read_b64_tr_b16 v[170:171], v9 offset:30720
    s_waitcnt lgkmcnt(12)
    v_mfma_f32_16x16x32_bf16 v[44:47], v[144:147], v[100:103], v[44:47]
    ds_read_b64_tr_b16 v[140:141], v9 offset:32768
    ds_read_b64_tr_b16 v[142:143], v9 offset:34816
    s_waitcnt lgkmcnt(12)
    v_mfma_f32_16x16x32_bf16 v[40:43], v[148:151], v[104:107], v[40:43]
    ds_read_b64_tr_b16 v[144:145], v9 offset:36864
    ds_read_b64_tr_b16 v[146:147], v9 offset:38912
    s_waitcnt lgkmcnt(12)
    v_mfma_f32_16x16x32_bf16 v[44:47], v[152:155], v[108:111], v[44:47]
    s_waitcnt lgkmcnt(10)
    v_mfma_f32_16x16x32_bf16 v[40:43], v[156:159], v[112:115], v[40:43]
    s_waitcnt lgkmcnt(8)
    v_mfma_f32_16x16x32_bf16 v[44:47], v[160:163], v[116:119], v[44:47]
    s_waitcnt lgkmcnt(6)
    v_mfma_f32_16x16x32_bf16 v[40:43], v[164:167], v[120:123], v[40:43]
    s_waitcnt lgkmcnt(4)
    v_mfma_f32_16x16x32_bf16 v[44:47], v[168:171], v[124:127], v[44:47]
    s_waitcnt lgkmcnt(2)
    v_mfma_f32_16x16x32_bf16 v[40:43], v[140:143], v[128:131], v[40:43]
    s_waitcnt lgkmcnt(0)
    v_mfma_f32_16x16x32_bf16 v[44:47], v[144:147], v[132:135], v[44:47]
    s_nop 7
    v_add_f32 v40, v40, v44
    v_add_f32 v41, v41, v45
    v_add_f32 v42, v42, v46
    v_add_f32 v43, v43, v47
    v_cvt_pk_bf16_f32 v44, v40, v41
    v_cvt_pk_bf16_f32 v45, v42, v43
    v_min_u32 v44, -2, v44
    v_min_u32 v45, -2, v45
    ds_write_b64 v6, v[44:45]
    s_waitcnt lgkmcnt(0)
    v_mov_b32 v16, 151620
    v_mov_b32 v17, 1
    s_mov_b64 exec, 1
    ds_add_u32 v16, v17
    s_mov_b64 exec, -1
    v_mov_b32 v16, 151620
    s_mov_b32 s29, 1600000
L_wl_10:
    ds_read_b32 v17, v16
    s_sub_u32 s29, s29, 1
    s_cbranch_scc1 L_wl_10_x
    s_waitcnt lgkmcnt(0)
    v_readfirstlane_b32 s28, v17
    s_cmp_ge_u32 s28, 4
    s_nop 2
    s_cbranch_scc1 L_wl_10_x
    s_branch L_wl_10
L_wl_10_x:
    s_waitcnt lgkmcnt(0)
    s_cmp_lg_u32 s3, 0
    s_cbranch_scc1 L_pqs_11
    v_add_u32 v6, 151680, v4
    s_lshl_b32 s38, s2, 10
    s_add_u32 s38, s38, 327680
    s_mov_b32 exec_hi, 0
    ds_read_b128 v[40:43], v6
    s_waitcnt lgkmcnt(0)
    buffer_store_dwordx4 v[40:43], v4, s[4:7], s38 offen sc1
    s_mov_b64 exec, -1
L_pqs_11:
    s_cmp_ge_u32 s2, 64
    s_cbranch_scc1 L_t1b_12
    s_cmp_lg_u32 s3, 1
    s_cbranch_scc1 L_fin
    s_and_b32 s52, s45, 15
    s_lshl_b32 s53, s52, 2
    s_add_u32 s53, s53, 64
    v_bfe_u32 v40, v0, 3, 2
    v_add_u32 v41, s53, v40
    v_lshlrev_b32 v41, 7, v41
    v_add_u32 v41, 32768, v41
    s_lshl_b32 s53, s45, 12
    s_add_u32 s53, s53, 66432
    v_mov_b32 v42, s53
    v_cmp_lt_u32 vcc, 31, v0
    s_nop 1
    v_cndmask_b32 v41, v41, v42, vcc
    v_and_b32 v42, 7, v0
    v_lshlrev_b32 v42, 4, v42
    v_lshl_add_u32 v42, v40, 10, v42
    s_lshl_b32 s52, s52, 12
    s_lshr_b32 s53, s45, 4
    s_lshl_b32 s53, s53, 7
    s_add_u32 s52, s52, s53
    s_add_u32 s52, s52, 393216
    v_lshlrev_b32 v43, 4, v0
    v_add_u32 v43, 158080, v43
    s_mov_b32 s29, 200000
L_cf_13:
    buffer_load_dword v49, v41, s[4:7], 0 offen sc1
    s_sub_u32 s29, s29, 1
    s_cbranch_scc1 L_cf_13_x
    s_waitcnt vmcnt(0)
    v_cmp_ne_u32 vcc, s63, v49
    s_nop 3
    s_cbranch_vccz L_cf_13_x
    s_mov_b64 exec, vcc
    s_sleep 4
    s_branch L_cf_13
L_cf_13_x:
    s_mov_b64 exec, -1
    s_waitcnt vmcnt(0)
    s_mov_b32 exec_hi, 0
    s_mov_b32 s29, 200000
L_poll_14:
    buffer_load_dwordx4 v[44:47], v42, s[4:7], s52 offen sc1
    s_sub_u32 s29, s29, 1
    s_cbranch_scc1 L_poll_14_x
    s_waitcnt vmcnt(0)
    v_max3_u32 v48, v44, v45, v46
    v_max_u32 v48, v48, v47
    v_cmp_eq_u32 vcc, -1, v48
    s_nop 3
    s_cbranch_vccz L_poll_14_x
    s_mov_b64 exec, vcc
    s_sleep 2
    s_branch L_poll_14
L_poll_14_x:
    s_mov_b64 exec, -1
    s_waitcnt vmcnt(0)
    s_mov_b32 exec_hi, 0
    ds_write_b128 v43, v[44:47]
    v_mov_b32 v48, 151652
    v_mov_b32 v49, 1
    ds_write_b32 v48, v49
    s_mov_b64 exec, -1
    s_branch L_fin
L_t1b_12:
    s_mov_b32 s20, s76
    s_mov_b32 s21, s77
    s_mov_b32 s22, 16777216
    s_mov_b32 s23, 0x20000
    v_xor_b32 v24, 0, v4
    v_xor_b32 v25, 32, v4
    v_xor_b32 v26, 64, v4
    v_xor_b32 v27, 96, v4
    v_xor_b32 v28, 128, v4
    v_xor_b32 v29, 160, v4
    v_xor_b32 v30, 192, v4
    v_xor_b32 v31, 224, v4
    v_xor_b32 v32, 16, v4
    v_xor_b32 v33, 48, v4
    v_xor_b32 v34, 80, v4
    v_xor_b32 v35, 112, v4
    v_xor_b32 v36, 144, v4
    v_xor_b32 v37, 176, v4
    v_xor_b32 v38, 208, v4
    v_xor_b32 v39, 240, v4
    s_sub_u32 s33, s2, 64
    s_lshr_b32 s36, s33, 1
    s_lshl_b32 s36, s36, 19
    s_and_b32 s37, s33, 1
    s_lshl_b32 s37, s37, 14
    s_add_u32 s36, s36, s37
    s_add_u32 s38, s3, 4
    s_lshl_b32 s37, s38, 14
    s_lshl_b32 s34, s38, 11
    s_add_u32 s34, s36, s34
    s_mov_b32 m0, s37
    s_waitcnt vmcnt(7)
    buffer_load_dwordx4 v24, s[20:23], s34 offen offset:0 nt lds
    s_add_u32 s34, s34, 32768
    s_add_u32 s37, s37, 1024
    s_mov_b32 m0, s37
    s_waitcnt vmcnt(7)
    buffer_load_dwordx4 v25, s[20:23], s34 offen offset:0 nt lds
    s_add_u32 s34, s34, 32768
    s_add_u32 s37, s37, 1024
    s_mov_b32 m0, s37
    s_waitcnt vmcnt(7)
    buffer_load_dwordx4 v26, s[20:23], s34 offen offset:0 nt lds
    s_add_u32 s34, s34, 32768
    s_add_u32 s37, s37, 1024
    s_mov_b32 m0, s37
    s_waitcnt vmcnt(7)
    buffer_load_dwordx4 v27, s[20:23], s34 offen offset:0 nt lds
    s_add_u32 s34, s34, 32768
    s_add_u32 s37, s37, 1024
    s_mov_b32 m0, s37
    s_waitcnt vmcnt(7)
    buffer_load_dwordx4 v28, s[20:23], s34 offen offset:0 nt lds
    s_add_u32 s34, s34, 32768
    s_add_u32 s37, s37, 1024
    s_mov_b32 m0, s37
    s_waitcnt vmcnt(7)
    buffer_load_dwordx4 v29, s[20:23], s34 offen offset:0 nt lds
    s_add_u32 s34, s34, 32768
    s_add_u32 s37, s37, 1024
    s_mov_b32 m0, s37
    s_waitcnt vmcnt(7)
    buffer_load_dwordx4 v30, s[20:23], s34 offen offset:0 nt lds
    s_add_u32 s34, s34, 32768
    s_add_u32 s37, s37, 1024
    s_mov_b32 m0, s37
    s_waitcnt vmcnt(7)
    buffer_load_dwordx4 v31, s[20:23], s34 offen offset:0 nt lds
    s_add_u32 s34, s34, 32768
    s_add_u32 s37, s37, 1024
    s_mov_b32 m0, s37
    s_waitcnt vmcnt(7)
    buffer_load_dwordx4 v32, s[20:23], s34 offen offset:0 nt lds
    s_add_u32 s34, s34, 32768
    s_add_u32 s37, s37, 1024
    s_mov_b32 m0, s37
    s_waitcnt vmcnt(7)
    buffer_load_dwordx4 v33, s[20:23], s34 offen offset:0 nt lds
    s_add_u32 s34, s34, 32768
    s_add_u32 s37, s37, 1024
    s_mov_b32 m0, s37
    s_waitcnt vmcnt(7)
    buffer_load_dwordx4 v34, s[20:23], s34 offen offset:0 nt lds
    s_add_u32 s34, s34, 32768
    s_add_u32 s37, s37, 1024
    s_mov_b32 m0, s37
    s_waitcnt vmcnt(7)
    buffer_load_dwordx4 v35, s[20:23], s34 offen offset:0 nt lds
    s_add_u32 s34, s34, 32768
    s_add_u32 s37, s37, 1024
    s_mov_b32 m0, s37
    s_waitcnt vmcnt(7)
    buffer_load_dwordx4 v36, s[20:23], s34 offen offset:0 nt lds
    s_add_u32 s34, s34, 32768
    s_add_u32 s37, s37, 1024
    s_mov_b32 m0, s37
    s_waitcnt vmcnt(7)
    buffer_load_dwordx4 v37, s[20:23], s34 offen offset:0 nt lds
    s_add_u32 s34, s34, 32768
    s_add_u32 s37, s37, 1024
    s_mov_b32 m0, s37
    s_waitcnt vmcnt(7)
    buffer_load_dwordx4 v38, s[20:23], s34 offen offset:0 nt lds
    s_add_u32 s34, s34, 32768
    s_add_u32 s37, s37, 1024
    s_mov_b32 m0, s37
    s_waitcnt vmcnt(7)
    buffer_load_dwordx4 v39, s[20:23], s34 offen offset:0 nt lds
    s_add_u32 s34, s34, 32768
    s_add_u32 s37, s37, 1024
    s_lshl_b32 s35, s3, 11
    s_add_u32 s35, s36, s35
    s_add_u32 s35, s35, 1024
    s_branch L_ba_c
L_ba_a:
    s_mov_b32 s20, s76
    s_mov_b32 s21, s77
    s_mov_b32 s22, 16777216
    s_mov_b32 s23, 0x20000
    v_xor_b32 v24, 0, v4
    v_xor_b32 v25, 32, v4
    v_xor_b32 v26, 64, v4
    v_xor_b32 v27, 96, v4
    v_xor_b32 v28, 128, v4
    v_xor_b32 v29, 160, v4
    v_xor_b32 v30, 192, v4
    v_xor_b32 v31, 224, v4
    v_xor_b32 v32, 16, v4
    v_xor_b32 v33, 48, v4
    v_xor_b32 v34, 80, v4
    v_xor_b32 v35, 112, v4
    v_xor_b32 v36, 144, v4
    v_xor_b32 v37, 176, v4
    v_xor_b32 v38, 208, v4
    v_xor_b32 v39, 240, v4
    s_sub_u32 s33, s2, 64
    s_lshr_b32 s36, s33, 1
    s_lshl_b32 s36, s36, 19
    s_and_b32 s37, s33, 1
    s_lshl_b32 s37, s37, 14
    s_add_u32 s36, s36, s37
    v_mov_b32 v16, 151656
    s_mov_b32 s29, 1600000
L_wl_15:
    ds_read_b32 v17, v16
    s_sub_u32 s29, s29, 1
    s_cbranch_scc1 L_wl_15_x
    s_waitcnt lgkmcnt(0)
    v_readfirstlane_b32 s28, v17
    s_cmp_ge_u32 s28, 1
    s_nop 2
    s_cbranch_scc1 L_wl_15_x
    s_sleep 1
    s_branch L_wl_15
L_wl_15_x:
    s_waitcnt lgkmcnt(0)
    s_lshl_b32 s37, s44, 14
    s_lshl_b32 s34, s44, 11
    s_add_u32 s34, s36, s34
    s_mov_b32 m0, s37
    s_waitcnt vmcnt(7)
    buffer_load_dwordx4 v24, s[20:23], s34 offen offset:0 nt lds
    s_add_u32 s34, s34, 32768
    s_add_u32 s37, s37, 1024
    s_mov_b32 m0, s37
    s_waitcnt vmcnt(7)
    buffer_load_dwordx4 v25, s[20:23], s34 offen offset:0 nt lds
    s_add_u32 s34, s34, 32768
    s_add_u32 s37, s37, 1024
    s_mov_b32 m0, s37
    s_waitcnt vmcnt(7)
    buffer_load_dwordx4 v26, s[20:23], s34 offen offset:0 nt lds
    s_add_u32 s34, s34, 32768
    s_add_u32 s37, s37, 1024
    s_mov_b32 m0, s37
    s_waitcnt vmcnt(7)
    buffer_load_dwordx4 v27, s[20:23], s34 offen offset:0 nt lds
    s_add_u32 s34, s34, 32768
    s_add_u32 s37, s37, 1024
    s_mov_b32 m0, s37
    s_waitcnt vmcnt(7)
    buffer_load_dwordx4 v28, s[20:23], s34 offen offset:0 nt lds
    s_add_u32 s34, s34, 32768
    s_add_u32 s37, s37, 1024
    s_mov_b32 m0, s37
    s_waitcnt vmcnt(7)
    buffer_load_dwordx4 v29, s[20:23], s34 offen offset:0 nt lds
    s_add_u32 s34, s34, 32768
    s_add_u32 s37, s37, 1024
    s_mov_b32 m0, s37
    s_waitcnt vmcnt(7)
    buffer_load_dwordx4 v30, s[20:23], s34 offen offset:0 nt lds
    s_add_u32 s34, s34, 32768
    s_add_u32 s37, s37, 1024
    s_mov_b32 m0, s37
    s_waitcnt vmcnt(7)
    buffer_load_dwordx4 v31, s[20:23], s34 offen offset:0 nt lds
    s_add_u32 s34, s34, 32768
    s_add_u32 s37, s37, 1024
    s_mov_b32 m0, s37
    s_waitcnt vmcnt(7)
    buffer_load_dwordx4 v32, s[20:23], s34 offen offset:0 nt lds
    s_add_u32 s34, s34, 32768
    s_add_u32 s37, s37, 1024
    s_mov_b32 m0, s37
    s_waitcnt vmcnt(7)
    buffer_load_dwordx4 v33, s[20:23], s34 offen offset:0 nt lds
    s_add_u32 s34, s34, 32768
    s_add_u32 s37, s37, 1024
    s_mov_b32 m0, s37
    s_waitcnt vmcnt(7)
    buffer_load_dwordx4 v34, s[20:23], s34 offen offset:0 nt lds
    s_add_u32 s34, s34, 32768
    s_add_u32 s37, s37, 1024
    s_mov_b32 m0, s37
    s_waitcnt vmcnt(7)
    buffer_load_dwordx4 v35, s[20:23], s34 offen offset:0 nt lds
    s_add_u32 s34, s34, 32768
    s_add_u32 s37, s37, 1024
    s_mov_b32 m0, s37
    s_waitcnt vmcnt(7)
    buffer_load_dwordx4 v36, s[20:23], s34 offen offset:0 nt lds
    s_add_u32 s34, s34, 32768
    s_add_u32 s37, s37, 1024
    s_mov_b32 m0, s37
    s_waitcnt vmcnt(7)
    buffer_load_dwordx4 v37, s[20:23], s34 offen offset:0 nt lds
    s_add_u32 s34, s34, 32768
    s_add_u32 s37, s37, 1024
    s_mov_b32 m0, s37
    s_waitcnt vmcnt(7)
    buffer_load_dwordx4 v38, s[20:23], s34 offen offset:0 nt lds
    s_add_u32 s34, s34, 32768
    s_add_u32 s37, s37, 1024
    s_mov_b32 m0, s37
    s_waitcnt vmcnt(7)
    buffer_load_dwordx4 v39, s[20:23], s34 offen offset:0 nt lds
    s_add_u32 s34, s34, 32768
    s_add_u32 s37, s37, 1024
    s_lshl_b32 s35, s3, 11
    s_add_u32 s35, s36, s35
    s_add_u32 s35, s35, 1024
    v_mov_b32 v16, 151664
    s_mov_b32 s29, 1600000
L_wl_16:
    ds_read_b32 v17, v16
    s_sub_u32 s29, s29, 1
    s_cbranch_scc1 L_wl_16_x
    s_waitcnt lgkmcnt(0)
    v_readfirstlane_b32 s28, v17
    s_cmp_ge_u32 s28, 1
    s_nop 2
    s_cbranch_scc1 L_wl_16_x
    s_sleep 1
    s_branch L_wl_16
L_wl_16_x:
    s_waitcnt lgkmcnt(0)
    ds_read_b32 v17, v16 offset:4
    s_waitcnt lgkmcnt(0)
    v_readfirstlane_b32 s63, v17
    s_cmp_lg_u32 s3, 4
    s_nop 2
    s_cbranch_scc1 L_noq_17
    s_and_b32 s52, s45, 15
    s_lshl_b32 s53, s52, 2
    s_add_u32 s53, s53, 64
    v_bfe_u32 v40, v0, 3, 2
    v_add_u32 v41, s53, v40
    v_lshlrev_b32 v41, 7, v41
    v_add_u32 v41, 32768, v41
    s_lshl_b32 s53, s45, 12
    s_add_u32 s53, s53, 66432
    v_mov_b32 v42, s53
    v_cmp_lt_u32 vcc, 31, v0
    s_nop 1
    v_cndmask_b32 v41, v41, v42, vcc
    v_and_b32 v42, 7, v0
    v_lshlrev_b32 v42, 4, v42
    v_lshl_add_u32 v42, v40, 10, v42
    s_lshl_b32 s52, s52, 12
    s_lshr_b32 s53, s45, 4
    s_lshl_b32 s53, s53, 7
    s_add_u32 s52, s52, s53
    s_add_u32 s52, s52, 393216
    v_lshlrev_b32 v43, 4, v0
    v_add_u32 v43, 158080, v43
    s_mov_b32 s29, 200000
L_cf_18:
    buffer_load_dword v49, v41, s[4:7], 0 offen sc1
    s_sub_u32 s29, s29, 1
    s_cbranch_scc1 L_cf_18_x
    s_waitcnt vmcnt(0)
    v_cmp_ne_u32 vcc, s63, v49
    s_nop 3
    s_cbranch_vccz L_cf_18_x
    s_mov_b64 exec, vcc
    s_sleep 4
    s_branch L_cf_18
L_cf_18_x:
    s_mov_b64 exec, -1
    s_waitcnt vmcnt(0)
    s_mov_b32 exec_hi, 0
    s_mov_b32 s29, 200000
L_poll_19:
    buffer_load_dwordx4 v[44:47], v42, s[4:7], s52 offen sc1
    s_sub_u32 s29, s29, 1
    s_cbranch_scc1 L_poll_19_x
    s_waitcnt vmcnt(0)
    v_max3_u32 v48, v44, v45, v46
    v_max_u32 v48, v48, v47
    v_cmp_eq_u32 vcc, -1, v48
    s_nop 3
    s_cbranch_vccz L_poll_19_x
    s_mov_b64 exec, vcc
    s_sleep 2
    s_branch L_poll_19
L_poll_19_x:
    s_mov_b64 exec, -1
    s_waitcnt vmcnt(0)
    s_mov_b32 exec_hi, 0
    ds_write_b128 v43, v[44:47]
    v_mov_b32 v48, 151652
    v_mov_b32 v49, 1
    ds_write_b32 v48, v49
    s_mov_b64 exec, -1
L_noq_17:
    s_setprio 2
L_ba_c:
    s_and_b32 s38, s3, 1
    s_lshr_b32 s43, s3, 1
    v_and_b32 v5, 7, v2
    v_lshlrev_b32 v5, 1, v5
    v_lshrrev_b32 v6, 3, v2
    v_or_b32 v5, v5, v6
    v_lshlrev_b32 v5, 4, v5
    v_lshl_add_u32 v5, v1, 8, v5
    v_lshl_add_u32 v5, v2, 10, v5
    s_lshl_b32 s37, s43, 15
    v_add_u32 v5, s37, v5
    s_lshr_b32 s39, s33, 4
    s_lshl_b32 s39, s39, 9
    s_lshl_b32 s40, s3, 13
    s_add_u32 s39, s39, s40
    s_add_u32 s39, s39, 458752
    s_add_u32 s40, s39, 4096
    s_add_u32 s41, s39, 65536
    s_add_u32 s42, s39, 69632
    v_lshrrev_b32 v10, 5, v0
    v_lshlrev_b32 v10, 11, v10
    v_and_b32 v11, 31, v0
    v_lshl_add_u32 v10, v11, 4, v10
    v_mov_b32 v3, 1040356334
    v_add_u32 v11, 128, v11
    s_lshl_b32 s37, s3, 5
    v_xor_b32 v12, s37, v4
    s_lshl_b32 s37, s3, 11
    s_add_u32 s37, s37, 131072
    v_add_u32 v12, s37, v12
    v_xor_b32 v13, 16, v12
    v_add_u32 v13, 1024, v13
    v_xor_b32 v14, v1, v2
    v_lshlrev_b32 v14, 4, v14
    v_lshl_add_u32 v14, v2, 10, v14
    v_add_u32 v14, 131072, v14
    v_xor_b32 v15, 64, v14
    v_xor_b32 v18, 0x80, v14
    v_xor_b32 v19, 0xc0, v14
    v_lshlrev_b32 v11, 7, v11
    v_add_u32 v11, 32768, v11
    s_mov_b32 s29, 200000
L_cf_20:
    buffer_load_dword v17, v11, s[4:7], 0 offen sc1
    s_sub_u32 s29, s29, 1
    s_cbranch_scc1 L_cf_20_x
    s_waitcnt vmcnt(0)
    v_cmp_ne_u32 vcc, s63, v17
    s_nop 3
    s_cbranch_vccz L_cf_20_x
    s_mov_b64 exec, vcc
    s_sleep 4
    s_branch L_cf_20
L_cf_20_x:
    s_mov_b64 exec, -1
    s_waitcnt vmcnt(0)
    s_waitcnt vmcnt(0)
    s_barrier
    s_mov_b32 s29, 200000
L_fp_21:
    buffer_load_dwordx4 v[40:43], v10, s[4:7], s39 offen sc1
    buffer_load_dwordx4 v[44:47], v10, s[4:7], s40 offen sc1
    buffer_load_dwordx4 v[48:51], v10, s[4:7], s41 offen sc1
    buffer_load_dwordx4 v[52:55], v10, s[4:7], s42 offen sc1
    s_sub_u32 s29, s29, 1
    s_cbranch_scc1 L_fp_21_x
    s_waitcnt vmcnt(0)
    v_max3_u32 v16, v40, v41, v42
    v_max3_u32 v16, v16, v43, v44
    v_max3_u32 v16, v16, v45, v46
    v_max3_u32 v16, v16, v47, v48
    v_max3_u32 v16, v16, v49, v50
    v_max3_u32 v16, v16, v51, v52
    v_max3_u32 v16, v16, v53, v54
    v_max_u32 v16, v16, v55
    v_cmp_eq_u32 vcc, -1, v16
    s_nop 3
    s_cbranch_vccz L_fp_21_x
    s_mov_b64 exec, vcc
    s_sleep 2
    s_branch L_fp_21
L_fp_21_x:
    s_mov_b64 exec, -1
    v_xor_b32 v23, 0, v4
    buffer_load_dwordx4 v[192:195], v23, s[20:23], s35 offen nt
    s_add_u32 s35, s35, 32768
    v_xor_b32 v23, 32, v4
    buffer_load_dwordx4 v[196:199], v23, s[20:23], s35 offen nt
    s_add_u32 s35, s35, 32768
    v_xor_b32 v23, 64, v4
    buffer_load_dwordx4 v[200:203], v23, s[20:23], s35 offen nt
    s_add_u32 s35, s35, 32768
    v_xor_b32 v23, 96, v4
    buffer_load_dwordx4 v[204:207], v23, s[20:23], s35 offen nt
    s_add_u32 s35, s35, 32768
    ds_write_b128 v12, v[40:43]
    ds_write_b128 v13, v[44:47]
    s_waitcnt lgkmcnt(0)
    s_barrier
    s_cmp_lg_u32 s38, 0
    s_cbranch_scc1 L_qs_22
    ds_read_b128 v[64:67], v14 offset:0
    ds_read_b128 v[68:71], v15 offset:0
    ds_read_b128 v[72:75], v18 offset:0
    ds_read_b128 v[76:79], v19 offset:0
    ds_read_b128 v[80:83], v14 offset:256
    ds_read_b128 v[84:87], v15 offset:256
    ds_read_b128 v[88:91], v18 offset:256
    ds_read_b128 v[92:95], v19 offset:256
    ds_read_b128 v[96:99], v14 offset:512
    ds_read_b128 v[100:103], v15 offset:512
    ds_read_b128 v[104:107], v18 offset:512
    ds_read_b128 v[108:111], v19 offset:512
    s_waitcnt lgkmcnt(8)
    ds_read_b128 v[112:115], v14 offset:768
    ds_read_b128 v[116:119], v15 offset:768
    ds_read_b128 v[120:123], v18 offset:768
    ds_read_b128 v[124:127], v19 offset:768
    s_waitcnt lgkmcnt(0)
L_qs_22:
    v_xor_b32 v23, 128, v4
    buffer_load_dwordx4 v[208:211], v23, s[20:23], s35 offen nt
    s_add_u32 s35, s35, 32768
    v_xor_b32 v23, 160, v4
    buffer_load_dwordx4 v[212:215], v23, s[20:23], s35 offen nt
    s_add_u32 s35, s35, 32768
    s_barrier
    ds_write_b128 v12, v[48:51]
    ds_write_b128 v13, v[52:55]
    s_waitcnt lgkmcnt(0)
    s_barrier
    s_cmp_lg_u32 s38, 1
    s_cbranch_scc1 L_qs_23
    ds_read_b128 v[64:67], v14 offset:0
    ds_read_b128 v[68:71], v15 offset:0
    ds_read_b128 v[72:75], v18 offset:0
    ds_read_b128 v[76:79], v19 offset:0
    ds_read_b128 v[80:83], v14 offset:256
    ds_read_b128 v[84:87], v15 offset:256
    ds_read_b128 v[88:91], v18 offset:256
    ds_read_b128 v[92:95], v19 offset:256
    ds_read_b128 v[96:99], v14 offset:512
    ds_read_b128 v[100:103], v15 offset:512
    ds_read_b128 v[104:107], v18 offset:512
    ds_read_b128 v[108:111], v19 offset:512
    s_waitcnt lgkmcnt(8)
    ds_read_b128 v[112:115], v14 offset:768
    ds_read_b128 v[116:119], v15 offset:768
    ds_read_b128 v[120:123], v18 offset:768
    ds_read_b128 v[124:127], v19 offset:768
    s_waitcnt lgkmcnt(0)
L_qs_23:
    v_xor_b32 v23, 192, v4
    buffer_load_dwordx4 v[216:219], v23, s[20:23], s35 offen nt
    s_add_u32 s35, s35, 32768
    v_xor_b32 v23, 224, v4
    buffer_load_dwordx4 v[220:223], v23, s[20:23], s35 offen nt
    s_add_u32 s35, s35, 32768
    v_lshlrev_b32 v12, 4, v2
    v_add_u32 v12, 151680, v12
    s_lshl_b32 s37, s38, 8
    s_lshl_b32 s39, s43, 2
    s_add_u32 s37, s37, s39
    v_add_u32 v13, s37, v12
    s_lshl_b32 s37, s38, 12
    s_lshl_b32 s39, s43, 10
    s_add_u32 s37, s37, s39
    s_add_u32 s37, s37, 131072
    v_add_u32 v14, s37, v4
    v_add_u32 v15, 131072, v4
    v_lshrrev_b32 v6, 2, v0
    v_and_b32 v7, 7, v6
    v_lshlrev_b32 v7, 1, v7
    v_lshrrev_b32 v8, 3, v6
    v_or_b32 v7, v7, v8
    v_bfe_u32 v8, v0, 1, 1
    v_xor_b32 v7, v7, v8
    v_lshlrev_b32 v7, 4, v7
    v_lshl_add_u32 v7, v6, 10, v7
    v_and_b32 v8, 1, v0
    v_lshl_add_u32 v7, v8, 3, v7
    s_lshl_b32 s41, s3, 7
    v_xor_b32 v7, s41, v7
    s_lshl_b32 s37, s3, 14
    v_add_u32 v18, s37, v4
    v_mov_b32 v10, 4286578687
    v_mov_b32 v11, 4286578687
    v_mov_b32 v19, 0
    s_waitcnt vmcnt(8)
    v_xor_b32 v24, 0, v7
    v_add_u32 v28, 0x10000, v24
    v_xor_b32 v25, 32, v7
    v_add_u32 v29, 0x10000, v25
    v_xor_b32 v26, 64, v7
    v_add_u32 v30, 0x10000, v26
    v_xor_b32 v27, 96, v7
    v_add_u32 v31, 0x10000, v27
    v_xor_b32 v32, 0, v5
    ds_read_b128 v[128:131], v32 offset:0
    ds_read_b128 v[132:135], v32 offset:16384
    v_xor_b32 v33, 16, v5
    ds_read_b128 v[136:139], v33 offset:0
    ds_read_b128 v[140:143], v33 offset:16384
    v_xor_b32 v34, 32, v5
    ds_read_b128 v[144:147], v34 offset:0
    ds_read_b128 v[148:151], v34 offset:16384
    v_xor_b32 v35, 48, v5
    ds_read_b128 v[152:155], v35 offset:0
    s_waitcnt lgkmcnt(6)
    v_mfma_f32_16x16x32_bf16 v[40:43], v[128:131], v[64:67], 0
    ds_read_b128 v[156:159], v35 offset:16384
    s_waitcnt lgkmcnt(6)
    v_mfma_f32_16x16x32_bf16 v[44:47], v[132:135], v[64:67], 0
    v_xor_b32 v32, 64, v5
    ds_read_b128 v[128:131], v32 offset:0
    s_waitcnt lgkmcnt(6)
    v_mfma_f32_16x16x32_bf16 v[40:43], v[136:139], v[68:71], v[40:43]
    ds_read_b128 v[132:135], v32 offset:16384
    s_waitcnt lgkmcnt(6)
    v_mfma_f32_16x16x32_bf16 v[44:47], v[140:143], v[68:71], v[44:47]
    v_xor_b32 v23, 16, v4
    buffer_load_dwordx4 v[224:227], v23, s[20:23], s35 offen nt
    s_add_u32 s35, s35, 32768
    v_xor_b32 v33, 80, v5
    ds_read_b128 v[136:139], v33 offset:0
    s_waitcnt lgkmcnt(6)
    v_mfma_f32_16x16x32_bf16 v[40:43], v[144:147], v[72:75], v[40:43]
    ds_read_b128 v[140:143], v33 offset:16384
    s_waitcnt lgkmcnt(6)
    v_mfma_f32_16x16x32_bf16 v[44:47], v[148:151], v[72:75], v[44:47]
    v_xor_b32 v34, 96, v5
    ds_read_b128 v[144:147], v34 offset:0
    s_waitcnt lgkmcnt(6)
    v_mfma_f32_16x16x32_bf16 v[40:43], v[152:155], v[76:79], v[40:43]
    ds_read_b128 v[148:151], v34 offset:16384
    s_waitcnt lgkmcnt(6)
    v_mfma_f32_16x16x32_bf16 v[44:47], v[156:159], v[76:79], v[44:47]
    v_xor_b32 v23, 48, v4
    buffer_load_dwordx4 v[228:231], v23, s[20:23], s35 offen nt
    s_add_u32 s35, s35, 32768
    v_xor_b32 v35, 112, v5
    ds_read_b128 v[152:155], v35 offset:0
    s_waitcnt lgkmcnt(6)
    v_mfma_f32_16x16x32_bf16 v[40:43], v[128:131], v[80:83], v[40:43]
    ds_read_b128 v[156:159], v35 offset:16384
    s_waitcnt lgkmcnt(6)
    v_mfma_f32_16x16x32_bf16 v[44:47], v[132:135], v[80:83], v[44:47]
    v_xor_b32 v32, 128, v5
    ds_read_b128 v[128:131], v32 offset:0
    s_waitcnt lgkmcnt(6)
    v_mfma_f32_16x16x32_bf16 v[40:43], v[136:139], v[84:87], v[40:43]
    ds_read_b128 v[132:135], v32 offset:16384
    s_waitcnt lgkmcnt(6)
    v_mfma_f32_16x16x32_bf16 v[44:47], v[140:143], v[84:87], v[44:47]
    v_xor_b32 v23, 80, v4
    buffer_load_dwordx4 v[232:235], v23, s[20:23], s35 offen nt
    s_add_u32 s35, s35, 32768
    v_xor_b32 v33, 144, v5
    ds_read_b128 v[136:139], v33 offset:0
    s_waitcnt lgkmcnt(6)
    v_mfma_f32_16x16x32_bf16 v[40:43], v[144:147], v[88:91], v[40:43]
    ds_read_b128 v[140:143], v33 offset:16384
    s_waitcnt lgkmcnt(6)
    v_mfma_f32_16x16x32_bf16 v[44:47], v[148:151], v[88:91], v[44:47]
    v_xor_b32 v34, 160, v5
    ds_read_b128 v[144:147], v34 offset:0
    s_waitcnt lgkmcnt(6)
    v_mfma_f32_16x16x32_bf16 v[40:43], v[152:155], v[92:95], v[40:43]
    ds_read_b128 v[148:151], v34 offset:16384
    s_waitcnt lgkmcnt(6)
    v_mfma_f32_16x16x32_bf16 v[44:47], v[156:159], v[92:95], v[44:47]
    v_xor_b32 v23, 112, v4
    buffer_load_dwordx4 v[236:239], v23, s[20:23], s35 offen nt
    s_add_u32 s35, s35, 32768
    v_xor_b32 v35, 176, v5
    ds_read_b128 v[152:155], v35 offset:0
    s_waitcnt lgkmcnt(6)
    v_mfma_f32_16x16x32_bf16 v[40:43], v[128:131], v[96:99], v[40:43]
    ds_read_b128 v[156:159], v35 offset:16384
    s_waitcnt lgkmcnt(6)
    v_mfma_f32_16x16x32_bf16 v[44:47], v[132:135], v[96:99], v[44:47]
    v_xor_b32 v32, 192, v5
    ds_read_b128 v[128:131], v32 offset:0
    s_waitcnt lgkmcnt(6)
    v_mfma_f32_16x16x32_bf16 v[40:43], v[136:139], v[100:103], v[40:43]
    ds_read_b128 v[132:135], v32 offset:16384
    s_waitcnt lgkmcnt(6)
    v_mfma_f32_16x16x32_bf16 v[44:47], v[140:143], v[100:103], v[44:47]
    v_xor_b32 v23, 144, v4
    buffer_load_dwordx4 v[240:243], v23, s[20:23], s35 offen nt
    s_add_u32 s35, s35, 32768
    v_xor_b32 v33, 208, v5
    ds_read_b128 v[136:139], v33 offset:0
    s_waitcnt lgkmcnt(6)
    v_mfma_f32_16x16x32_bf16 v[40:43], v[144:147], v[104:107], v[40:43]
    ds_read_b128 v[140:143], v33 offset:16384
    s_waitcnt lgkmcnt(6)
    v_mfma_f32_16x16x32_bf16 v[44:47], v[148:151], v[104:107], v[44:47]
    v_xor_b32 v34, 224, v5
    ds_read_b128 v[144:147], v34 offset:0
    s_waitcnt lgkmcnt(6)
    v_mfma_f32_16x16x32_bf16 v[40:43], v[152:155], v[108:111], v[40:43]
    ds_read_b128 v[148:151], v34 offset:16384
    s_waitcnt lgkmcnt(6)
    v_mfma_f32_16x16x32_bf16 v[44:47], v[156:159], v[108:111], v[44:47]
    v_xor_b32 v23, 176, v4
    buffer_load_dwordx4 v[244:247], v23, s[20:23], s35 offen nt
    s_add_u32 s35, s35, 32768
    v_xor_b32 v35, 240, v5
    ds_read_b128 v[152:155], v35 offset:0
    s_waitcnt lgkmcnt(6)
    v_mfma_f32_16x16x32_bf16 v[40:43], v[128:131], v[112:115], v[40:43]
    ds_read_b128 v[156:159], v35 offset:16384
    s_waitcnt lgkmcnt(6)
    v_mfma_f32_16x16x32_bf16 v[44:47], v[132:135], v[112:115], v[44:47]
    s_waitcnt lgkmcnt(5)
    v_mfma_f32_16x16x32_bf16 v[40:43], v[136:139], v[116:119], v[40:43]
    s_waitcnt lgkmcnt(4)
    v_mfma_f32_16x16x32_bf16 v[44:47], v[140:143], v[116:119], v[44:47]
    v_xor_b32 v23, 208, v4
    buffer_load_dwordx4 v[248:251], v23, s[20:23], s35 offen nt
    s_add_u32 s35, s35, 32768
    s_waitcnt lgkmcnt(3)
    v_mfma_f32_16x16x32_bf16 v[40:43], v[144:147], v[120:123], v[40:43]
    s_waitcnt lgkmcnt(2)
    v_mfma_f32_16x16x32_bf16 v[44:47], v[148:151], v[120:123], v[44:47]
    s_waitcnt lgkmcnt(1)
    v_mfma_f32_16x16x32_bf16 v[40:43], v[152:155], v[124:127], v[40:43]
    s_waitcnt lgkmcnt(0)
    v_mfma_f32_16x16x32_bf16 v[44:47], v[156:159], v[124:127], v[44:47]
    v_xor_b32 v23, 240, v4
    buffer_load_dwordx4 v[252:255], v23, s[20:23], s35 offen nt
    s_add_u32 s35, s35, 32768
    s_nop 2
    v_mul_f32 v40, v3, v40
    v_mul_f32 v41, v3, v41
    v_mul_f32 v42, v3, v42
    v_mul_f32 v43, v3, v43
    v_mul_f32 v44, v3, v44
    v_mul_f32 v45, v3, v45
    v_mul_f32 v46, v3, v46
    v_mul_f32 v47, v3, v47
    v_max3_f32 v8, v40, v41, v42
    v_max3_f32 v8, v8, v43, v44
    v_max3_f32 v8, v8, v45, v46
    v_max_f32 v8, v8, v47
    v_mov_b32 v9, v8
    s_nop 1
    v_permlane16_swap_b32 v8, v9
    v_max_f32 v8, v8, v9
    v_mov_b32 v9, v8
    s_nop 1
    v_permlane32_swap_b32 v8, v9
    v_max_f32 v8, v8, v9
    ds_write_b32 v13, v8
    s_waitcnt lgkmcnt(0)
    s_barrier
    ds_read_b128 v[52:55], v12
    ds_read_b128 v[56:59], v12 offset:256
    s_cmp_eq_u32 s38, 0
    s_cselect_b64 s[26:27], -1, 0
    s_waitcnt lgkmcnt(0)
    v_max3_f32 v52, v52, v53, v54
    v_max3_f32 v56, v56, v57, v58
    v_max3_f32 v52, v52, v55, v10
    v_max3_f32 v56, v56, v59, v11
    v_sub_f32 v60, v10, v52
    v_sub_f32 v61, v11, v56
    v_mov_b32 v10, v52
    v_mov_b32 v11, v56
    v_cndmask_b32 v8, v56, v52, s[26:27]
    v_exp_f32 v60, v60
    v_exp_f32 v61, v61
    v_sub_f32 v40, v40, v8
    v_sub_f32 v41, v41, v8
    v_sub_f32 v42, v42, v8
    v_sub_f32 v43, v43, v8
    v_sub_f32 v44, v44, v8
    v_sub_f32 v45, v45, v8
    v_sub_f32 v46, v46, v8
    v_sub_f32 v47, v47, v8
    v_exp_f32 v40, v40
    v_exp_f32 v41, v41
    v_exp_f32 v42, v42
    v_exp_f32 v43, v43
    v_exp_f32 v44, v44
    v_exp_f32 v45, v45
    v_exp_f32 v46, v46
    v_exp_f32 v47, v47
    v_cndmask_b32 v9, v61, v60, s[26:27]
    v_cvt_pk_bf16_f32 v48, v40, v41
    v_cvt_pk_bf16_f32 v49, v42, v43
    v_cvt_pk_bf16_f32 v50, v44, v45
    v_cvt_pk_bf16_f32 v51, v46, v47
    ds_write_b128 v14, v[48:51]
    v_fma_f32 v19, v19, v9, v40
    v_add_f32 v19, v19, v41
    v_add_f32 v19, v19, v42
    v_add_f32 v19, v19, v43
    v_add_f32 v19, v19, v44
    v_add_f32 v19, v19, v45
    v_add_f32 v19, v19, v46
    v_add_f32 v19, v19, v47
    s_waitcnt lgkmcnt(0)
    s_barrier
    ds_read_b128 v[40:43], v15 offset:0
    ds_read_b128 v[44:47], v15 offset:4096
    ds_read_b64_tr_b16 v[128:129], v24 offset:0
    ds_read_b64_tr_b16 v[130:131], v24 offset:16384
    ds_read_b64_tr_b16 v[132:133], v25 offset:0
    ds_read_b64_tr_b16 v[134:135], v25 offset:16384
    ds_read_b64_tr_b16 v[136:137], v26 offset:0
    ds_read_b64_tr_b16 v[138:139], v26 offset:16384
    ds_read_b64_tr_b16 v[140:141], v27 offset:0
    ds_read_b64_tr_b16 v[142:143], v27 offset:16384
    ds_read_b128 v[48:51], v15 offset:1024
    ds_read_b128 v[52:55], v15 offset:5120
    ds_read_b64_tr_b16 v[144:145], v24 offset:32768
    ds_read_b64_tr_b16 v[146:147], v24 offset:49152
    s_waitcnt lgkmcnt(10)
    v_mfma_f32_16x16x32_bf16 v[160:163], v[128:131], v[40:43], 0
    v_mfma_f32_16x16x32_bf16 v[176:179], v[128:131], v[44:47], 0
    ds_read_b64_tr_b16 v[148:149], v25 offset:32768
    ds_read_b64_tr_b16 v[150:151], v25 offset:49152
    s_waitcnt lgkmcnt(10)
    v_mfma_f32_16x16x32_bf16 v[164:167], v[132:135], v[40:43], 0
    v_mfma_f32_16x16x32_bf16 v[180:183], v[132:135], v[44:47], 0
    ds_read_b64_tr_b16 v[152:153], v26 offset:32768
    ds_read_b64_tr_b16 v[154:155], v26 offset:49152
    s_waitcnt lgkmcnt(10)
    v_mfma_f32_16x16x32_bf16 v[168:171], v[136:139], v[40:43], 0
    v_mfma_f32_16x16x32_bf16 v[184:187], v[136:139], v[44:47], 0
    ds_read_b64_tr_b16 v[156:157], v27 offset:32768
    ds_read_b64_tr_b16 v[158:159], v27 offset:49152
    s_waitcnt lgkmcnt(10)
    v_mfma_f32_16x16x32_bf16 v[172:175], v[140:143], v[40:43], 0
    v_mfma_f32_16x16x32_bf16 v[188:191], v[140:143], v[44:47], 0
    ds_read_b128 v[40:43], v15 offset:2048
    ds_read_b128 v[44:47], v15 offset:6144
    ds_read_b64_tr_b16 v[128:129], v28 offset:0
    ds_read_b64_tr_b16 v[130:131], v28 offset:16384
    s_waitcnt lgkmcnt(10)
    v_mfma_f32_16x16x32_bf16 v[160:163], v[144:147], v[48:51], v[160:163]
    v_mfma_f32_16x16x32_bf16 v[176:179], v[144:147], v[52:55], v[176:179]
    ds_read_b64_tr_b16 v[132:133], v29 offset:0
    ds_read_b64_tr_b16 v[134:135], v29 offset:16384
    s_waitcnt lgkmcnt(10)
    v_mfma_f32_16x16x32_bf16 v[164:167], v[148:151], v[48:51], v[164:167]
    v_mfma_f32_16x16x32_bf16 v[180:183], v[148:151], v[52:55], v[180:183]
    ds_read_b64_tr_b16 v[136:137], v30 offset:0
    ds_read_b64_tr_b16 v[138:139], v30 offset:16384
    s_waitcnt lgkmcnt(10)
    v_mfma_f32_16x16x32_bf16 v[168:171], v[152:155], v[48:51], v[168:171]
    v_mfma_f32_16x16x32_bf16 v[184:187], v[152:155], v[52:55], v[184:187]
    ds_read_b64_tr_b16 v[140:141], v31 offset:0
    ds_read_b64_tr_b16 v[142:143], v31 offset:16384
    s_waitcnt lgkmcnt(10)
    v_mfma_f32_16x16x32_bf16 v[172:175], v[156:159], v[48:51], v[172:175]
    v_mfma_f32_16x16x32_bf16 v[188:191], v[156:159], v[52:55], v[188:191]
    ds_read_b128 v[48:51], v15 offset:3072
    ds_read_b128 v[52:55], v15 offset:7168
    ds_read_b64_tr_b16 v[144:145], v28 offset:32768
    ds_read_b64_tr_b16 v[146:147], v28 offset:49152
    s_waitcnt lgkmcnt(10)
    v_mfma_f32_16x16x32_bf16 v[160:163], v[128:131], v[40:43], v[160:163]
    v_mfma_f32_16x16x32_bf16 v[176:179], v[128:131], v[44:47], v[176:179]
    ds_read_b64_tr_b16 v[148:149], v29 offset:32768
    ds_read_b64_tr_b16 v[150:151], v29 offset:49152
    s_waitcnt lgkmcnt(10)
    v_mfma_f32_16x16x32_bf16 v[164:167], v[132:135], v[40:43], v[164:167]
    v_mfma_f32_16x16x32_bf16 v[180:183], v[132:135], v[44:47], v[180:183]
    ds_read_b64_tr_b16 v[152:153], v30 offset:32768
    ds_read_b64_tr_b16 v[154:155], v30 offset:49152
    s_waitcnt lgkmcnt(10)
    v_mfma_f32_16x16x32_bf16 v[168:171], v[136:139], v[40:43], v[168:171]
    v_mfma_f32_16x16x32_bf16 v[184:187], v[136:139], v[44:47], v[184:187]
    ds_read_b64_tr_b16 v[156:157], v31 offset:32768
    ds_read_b64_tr_b16 v[158:159], v31 offset:49152
    s_waitcnt lgkmcnt(10)
    v_mfma_f32_16x16x32_bf16 v[172:175], v[140:143], v[40:43], v[172:175]
    v_mfma_f32_16x16x32_bf16 v[188:191], v[140:143], v[44:47], v[188:191]
    s_waitcnt lgkmcnt(6)
    v_mfma_f32_16x16x32_bf16 v[160:163], v[144:147], v[48:51], v[160:163]
    v_mfma_f32_16x16x32_bf16 v[176:179], v[144:147], v[52:55], v[176:179]
    s_waitcnt lgkmcnt(4)
    v_mfma_f32_16x16x32_bf16 v[164:167], v[148:151], v[48:51], v[164:167]
    v_mfma_f32_16x16x32_bf16 v[180:183], v[148:151], v[52:55], v[180:183]
    s_waitcnt lgkmcnt(2)
    v_mfma_f32_16x16x32_bf16 v[168:171], v[152:155], v[48:51], v[168:171]
    v_mfma_f32_16x16x32_bf16 v[184:187], v[152:155], v[52:55], v[184:187]
    s_waitcnt lgkmcnt(0)
    v_mfma_f32_16x16x32_bf16 v[172:175], v[156:159], v[48:51], v[172:175]
    v_mfma_f32_16x16x32_bf16 v[188:191], v[156:159], v[52:55], v[188:191]
    s_waitcnt vmcnt(0)
    s_barrier
    ds_write_b128 v18, v[192:195] offset:0
    ds_write_b128 v18, v[196:199] offset:1024
    ds_write_b128 v18, v[200:203] offset:2048
    ds_write_b128 v18, v[204:207] offset:3072
    ds_write_b128 v18, v[208:211] offset:4096
    ds_write_b128 v18, v[212:215] offset:5120
    ds_write_b128 v18, v[216:219] offset:6144
    ds_write_b128 v18, v[220:223] offset:7168
    ds_write_b128 v18, v[224:227] offset:8192
    ds_write_b128 v18, v[228:231] offset:9216
    ds_write_b128 v18, v[232:235] offset:10240
    ds_write_b128 v18, v[236:239] offset:11264
    ds_write_b128 v18, v[240:243] offset:12288
    ds_write_b128 v18, v[244:247] offset:13312
    ds_write_b128 v18, v[248:251] offset:14336
    ds_write_b128 v18, v[252:255] offset:15360
    s_waitcnt lgkmcnt(0)
    s_barrier
    v_xor_b32 v32, 0, v5
    ds_read_b128 v[128:131], v32 offset:0
    ds_read_b128 v[132:135], v32 offset:16384
    v_xor_b32 v33, 16, v5
    ds_read_b128 v[136:139], v33 offset:0
    ds_read_b128 v[140:143], v33 offset:16384
    v_xor_b32 v34, 32, v5
    ds_read_b128 v[144:147], v34 offset:0
    ds_read_b128 v[148:151], v34 offset:16384
    v_xor_b32 v35, 48, v5
    ds_read_b128 v[152:155], v35 offset:0
    s_waitcnt lgkmcnt(6)
    v_mfma_f32_16x16x32_bf16 v[40:43], v[128:131], v[64:67], 0
    ds_read_b128 v[156:159], v35 offset:16384
    s_waitcnt lgkmcnt(6)
    v_mfma_f32_16x16x32_bf16 v[44:47], v[132:135], v[64:67], 0
    v_xor_b32 v32, 64, v5
    ds_read_b128 v[128:131], v32 offset:0
    s_waitcnt lgkmcnt(6)
    v_mfma_f32_16x16x32_bf16 v[40:43], v[136:139], v[68:71], v[40:43]
    ds_read_b128 v[132:135], v32 offset:16384
    s_waitcnt lgkmcnt(6)
    v_mfma_f32_16x16x32_bf16 v[44:47], v[140:143], v[68:71], v[44:47]
    v_xor_b32 v33, 80, v5
    ds_read_b128 v[136:139], v33 offset:0
    s_waitcnt lgkmcnt(6)
    v_mfma_f32_16x16x32_bf16 v[40:43], v[144:147], v[72:75], v[40:43]
    ds_read_b128 v[140:143], v33 offset:16384
    s_waitcnt lgkmcnt(6)
    v_mfma_f32_16x16x32_bf16 v[44:47], v[148:151], v[72:75], v[44:47]
    v_xor_b32 v34, 96, v5
    ds_read_b128 v[144:147], v34 offset:0
    s_waitcnt lgkmcnt(6)
    v_mfma_f32_16x16x32_bf16 v[40:43], v[152:155], v[76:79], v[40:43]
    ds_read_b128 v[148:151], v34 offset:16384
    s_waitcnt lgkmcnt(6)
    v_mfma_f32_16x16x32_bf16 v[44:47], v[156:159], v[76:79], v[44:47]
    v_xor_b32 v35, 112, v5
    ds_read_b128 v[152:155], v35 offset:0
    s_waitcnt lgkmcnt(6)
    v_mfma_f32_16x16x32_bf16 v[40:43], v[128:131], v[80:83], v[40:43]
    ds_read_b128 v[156:159], v35 offset:16384
    s_waitcnt lgkmcnt(6)
    v_mfma_f32_16x16x32_bf16 v[44:47], v[132:135], v[80:83], v[44:47]
    v_xor_b32 v32, 128, v5
    ds_read_b128 v[128:131], v32 offset:0
    s_waitcnt lgkmcnt(6)
    v_mfma_f32_16x16x32_bf16 v[40:43], v[136:139], v[84:87], v[40:43]
    ds_read_b128 v[132:135], v32 offset:16384
    s_waitcnt lgkmcnt(6)
    v_mfma_f32_16x16x32_bf16 v[44:47], v[140:143], v[84:87], v[44:47]
    v_xor_b32 v33, 144, v5
    ds_read_b128 v[136:139], v33 offset:0
    s_waitcnt lgkmcnt(6)
    v_mfma_f32_16x16x32_bf16 v[40:43], v[144:147], v[88:91], v[40:43]
    ds_read_b128 v[140:143], v33 offset:16384
    s_waitcnt lgkmcnt(6)
    v_mfma_f32_16x16x32_bf16 v[44:47], v[148:151], v[88:91], v[44:47]
    v_xor_b32 v34, 160, v5
    ds_read_b128 v[144:147], v34 offset:0
    s_waitcnt lgkmcnt(6)
    v_mfma_f32_16x16x32_bf16 v[40:43], v[152:155], v[92:95], v[40:43]
    ds_read_b128 v[148:151], v34 offset:16384
    s_waitcnt lgkmcnt(6)
    v_mfma_f32_16x16x32_bf16 v[44:47], v[156:159], v[92:95], v[44:47]
    v_xor_b32 v35, 176, v5
    ds_read_b128 v[152:155], v35 offset:0
    s_waitcnt lgkmcnt(6)
    v_mfma_f32_16x16x32_bf16 v[40:43], v[128:131], v[96:99], v[40:43]
    ds_read_b128 v[156:159], v35 offset:16384
    s_waitcnt lgkmcnt(6)
    v_mfma_f32_16x16x32_bf16 v[44:47], v[132:135], v[96:99], v[44:47]
    v_xor_b32 v32, 192, v5
    ds_read_b128 v[128:131], v32 offset:0
    s_waitcnt lgkmcnt(6)
    v_mfma_f32_16x16x32_bf16 v[40:43], v[136:139], v[100:103], v[40:43]
    ds_read_b128 v[132:135], v32 offset:16384
    s_waitcnt lgkmcnt(6)
    v_mfma_f32_16x16x32_bf16 v[44:47], v[140:143], v[100:103], v[44:47]
    v_xor_b32 v33, 208, v5
    ds_read_b128 v[136:139], v33 offset:0
    s_waitcnt lgkmcnt(6)
    v_mfma_f32_16x16x32_bf16 v[40:43], v[144:147], v[104:107], v[40:43]
    ds_read_b128 v[140:143], v33 offset:16384
    s_waitcnt lgkmcnt(6)
    v_mfma_f32_16x16x32_bf16 v[44:47], v[148:151], v[104:107], v[44:47]
    v_xor_b32 v34, 224, v5
    ds_read_b128 v[144:147], v34 offset:0
    s_waitcnt lgkmcnt(6)
    v_mfma_f32_16x16x32_bf16 v[40:43], v[152:155], v[108:111], v[40:43]
    ds_read_b128 v[148:151], v34 offset:16384
    s_waitcnt lgkmcnt(6)
    v_mfma_f32_16x16x32_bf16 v[44:47], v[156:159], v[108:111], v[44:47]
    v_xor_b32 v35, 240, v5
    ds_read_b128 v[152:155], v35 offset:0
    s_waitcnt lgkmcnt(6)
    v_mfma_f32_16x16x32_bf16 v[40:43], v[128:131], v[112:115], v[40:43]
    ds_read_b128 v[156:159], v35 offset:16384
    s_waitcnt lgkmcnt(6)
    v_mfma_f32_16x16x32_bf16 v[44:47], v[132:135], v[112:115], v[44:47]
    s_waitcnt lgkmcnt(5)
    v_mfma_f32_16x16x32_bf16 v[40:43], v[136:139], v[116:119], v[40:43]
    s_waitcnt lgkmcnt(4)
    v_mfma_f32_16x16x32_bf16 v[44:47], v[140:143], v[116:119], v[44:47]
    s_waitcnt lgkmcnt(3)
    v_mfma_f32_16x16x32_bf16 v[40:43], v[144:147], v[120:123], v[40:43]
    s_waitcnt lgkmcnt(2)
    v_mfma_f32_16x16x32_bf16 v[44:47], v[148:151], v[120:123], v[44:47]
    s_waitcnt lgkmcnt(1)
    v_mfma_f32_16x16x32_bf16 v[40:43], v[152:155], v[124:127], v[40:43]
    s_waitcnt lgkmcnt(0)
    v_mfma_f32_16x16x32_bf16 v[44:47], v[156:159], v[124:127], v[44:47]
    s_nop 5
    v_mul_f32 v40, v3, v40
    v_mul_f32 v41, v3, v41
    v_mul_f32 v42, v3, v42
    v_mul_f32 v43, v3, v43
    v_mul_f32 v44, v3, v44
    v_mul_f32 v45, v3, v45
    v_mul_f32 v46, v3, v46
    v_mul_f32 v47, v3, v47
    v_max3_f32 v8, v40, v41, v42
    v_max3_f32 v8, v8, v43, v44
    v_max3_f32 v8, v8, v45, v46
    v_max_f32 v8, v8, v47
    v_mov_b32 v9, v8
    s_nop 1
    v_permlane16_swap_b32 v8, v9
    v_max_f32 v8, v8, v9
    v_mov_b32 v9, v8
    s_nop 1
    v_permlane32_swap_b32 v8, v9
    v_max_f32 v8, v8, v9
    ds_write_b32 v13, v8
    s_waitcnt lgkmcnt(0)
    s_barrier
    ds_read_b128 v[52:55], v12
    ds_read_b128 v[56:59], v12 offset:256
    s_cmp_eq_u32 s38, 0
    s_cselect_b64 s[26:27], -1, 0
    s_waitcnt lgkmcnt(0)
    v_max3_f32 v52, v52, v53, v54
    v_max3_f32 v56, v56, v57, v58
    v_max3_f32 v52, v52, v55, v10
    v_max3_f32 v56, v56, v59, v11
    v_sub_f32 v60, v10, v52
    v_sub_f32 v61, v11, v56
    v_mov_b32 v10, v52
    v_mov_b32 v11, v56
    v_cndmask_b32 v8, v56, v52, s[26:27]
    v_exp_f32 v60, v60
    v_exp_f32 v61, v61
    v_sub_f32 v40, v40, v8
    v_sub_f32 v41, v41, v8
    v_sub_f32 v42, v42, v8
    v_sub_f32 v43, v43, v8
    v_sub_f32 v44, v44, v8
    v_sub_f32 v45, v45, v8
    v_sub_f32 v46, v46, v8
    v_sub_f32 v47, v47, v8
    v_exp_f32 v40, v40
    v_exp_f32 v41, v41
    v_exp_f32 v42, v42
    v_exp_f32 v43, v43
    v_exp_f32 v44, v44
    v_exp_f32 v45, v45
    v_exp_f32 v46, v46
    v_exp_f32 v47, v47
    v_cndmask_b32 v9, v61, v60, s[26:27]
    v_cvt_pk_bf16_f32 v48, v40, v41
    v_cvt_pk_bf16_f32 v49, v42, v43
    v_cvt_pk_bf16_f32 v50, v44, v45
    v_cvt_pk_bf16_f32 v51, v46, v47
    ds_write_b128 v14, v[48:51]
    v_fma_f32 v19, v19, v9, v40
    v_add_f32 v19, v19, v41
    v_add_f32 v19, v19, v42
    v_add_f32 v19, v19, v43
    v_add_f32 v19, v19, v44
    v_add_f32 v19, v19, v45
    v_add_f32 v19, v19, v46
    v_add_f32 v19, v19, v47
    v_mul_f32 v160, v60, v160
    v_mul_f32 v161, v60, v161
    v_mul_f32 v162, v60, v162
    v_mul_f32 v163, v60, v163
    v_mul_f32 v164, v60, v164
    v_mul_f32 v165, v60, v165
    v_mul_f32 v166, v60, v166
    v_mul_f32 v167, v60, v167
    v_mul_f32 v168, v60, v168
    v_mul_f32 v169, v60, v169
    v_mul_f32 v170, v60, v170
    v_mul_f32 v171, v60, v171
    v_mul_f32 v172, v60, v172
    v_mul_f32 v173, v60, v173
    v_mul_f32 v174, v60, v174
    v_mul_f32 v175, v60, v175
    v_mul_f32 v176, v61, v176
    v_mul_f32 v177, v61, v177
    v_mul_f32 v178, v61, v178
    v_mul_f32 v179, v61, v179
    v_mul_f32 v180, v61, v180
    v_mul_f32 v181, v61, v181
    v_mul_f32 v182, v61, v182
    v_mul_f32 v183, v61, v183
    v_mul_f32 v184, v61, v184
    v_mul_f32 v185, v61, v185
    v_mul_f32 v186, v61, v186
    v_mul_f32 v187, v61, v187
    v_mul_f32 v188, v61, v188
    v_mul_f32 v189, v61, v189
    v_mul_f32 v190, v61, v190
    v_mul_f32 v191, v61, v191
    v_mov_b32 v9, v19
    s_nop 1
    v_permlane16_swap_b32 v19, v9
    v_add_f32 v19, v19, v9
    v_mov_b32 v9, v19
    s_nop 1
    v_permlane32_swap_b32 v19, v9
    v_add_f32 v19, v19, v9
    ds_write_b32 v13, v19 offset:512
    s_waitcnt lgkmcnt(0)
    s_barrier
    ds_read_b128 v[40:43], v15 offset:0
    ds_read_b128 v[44:47], v15 offset:4096
    ds_read_b64_tr_b16 v[128:129], v24 offset:0
    ds_read_b64_tr_b16 v[130:131], v24 offset:16384
    ds_read_b64_tr_b16 v[132:133], v25 offset:0
    ds_read_b64_tr_b16 v[134:135], v25 offset:16384
    ds_read_b64_tr_b16 v[136:137], v26 offset:0
    ds_read_b64_tr_b16 v[138:139], v26 offset:16384
    ds_read_b64_tr_b16 v[140:141], v27 offset:0
    ds_read_b64_tr_b16 v[142:143], v27 offset:16384
    ds_read_b128 v[48:51], v15 offset:1024
    ds_read_b128 v[52:55], v15 offset:5120
    ds_read_b64_tr_b16 v[144:145], v24 offset:32768
    ds_read_b64_tr_b16 v[146:147], v24 offset:49152
    s_waitcnt lgkmcnt(10)
    v_mfma_f32_16x16x32_bf16 v[160:163], v[128:131], v[40:43], v[160:163]
    v_mfma_f32_16x16x32_bf16 v[176:179], v[128:131], v[44:47], v[176:179]
    ds_read_b64_tr_b16 v[148:149], v25 offset:32768
    ds_read_b64_tr_b16 v[150:151], v25 offset:49152
    s_waitcnt lgkmcnt(10)
    v_mfma_f32_16x16x32_bf16 v[164:167], v[132:135], v[40:43], v[164:167]
    v_mfma_f32_16x16x32_bf16 v[180:183], v[132:135], v[44:47], v[180:183]
    ds_read_b64_tr_b16 v[152:153], v26 offset:32768
    ds_read_b64_tr_b16 v[154:155], v26 offset:49152
    s_waitcnt lgkmcnt(10)
    v_mfma_f32_16x16x32_bf16 v[168:171], v[136:139], v[40:43], v[168:171]
    v_mfma_f32_16x16x32_bf16 v[184:187], v[136:139], v[44:47], v[184:187]
    ds_read_b64_tr_b16 v[156:157], v27 offset:32768
    ds_read_b64_tr_b16 v[158:159], v27 offset:49152
    s_waitcnt lgkmcnt(10)
    v_mfma_f32_16x16x32_bf16 v[172:175], v[140:143], v[40:43], v[172:175]
    v_mfma_f32_16x16x32_bf16 v[188:191], v[140:143], v[44:47], v[188:191]
    ds_read_b128 v[40:43], v15 offset:2048
    ds_read_b128 v[44:47], v15 offset:6144
    ds_read_b64_tr_b16 v[128:129], v28 offset:0
    ds_read_b64_tr_b16 v[130:131], v28 offset:16384
    s_waitcnt lgkmcnt(10)
    v_mfma_f32_16x16x32_bf16 v[160:163], v[144:147], v[48:51], v[160:163]
    v_mfma_f32_16x16x32_bf16 v[176:179], v[144:147], v[52:55], v[176:179]
    ds_read_b64_tr_b16 v[132:133], v29 offset:0
    ds_read_b64_tr_b16 v[134:135], v29 offset:16384
    s_waitcnt lgkmcnt(10)
    v_mfma_f32_16x16x32_bf16 v[164:167], v[148:151], v[48:51], v[164:167]
    v_mfma_f32_16x16x32_bf16 v[180:183], v[148:151], v[52:55], v[180:183]
    ds_read_b64_tr_b16 v[136:137], v30 offset:0
    ds_read_b64_tr_b16 v[138:139], v30 offset:16384
    s_waitcnt lgkmcnt(10)
    v_mfma_f32_16x16x32_bf16 v[168:171], v[152:155], v[48:51], v[168:171]
    v_mfma_f32_16x16x32_bf16 v[184:187], v[152:155], v[52:55], v[184:187]
    ds_read_b64_tr_b16 v[140:141], v31 offset:0
    ds_read_b64_tr_b16 v[142:143], v31 offset:16384
    s_waitcnt lgkmcnt(10)
    v_mfma_f32_16x16x32_bf16 v[172:175], v[156:159], v[48:51], v[172:175]
    v_mfma_f32_16x16x32_bf16 v[188:191], v[156:159], v[52:55], v[188:191]
    ds_read_b128 v[48:51], v15 offset:3072
    ds_read_b128 v[52:55], v15 offset:7168
    ds_read_b64_tr_b16 v[144:145], v28 offset:32768
    ds_read_b64_tr_b16 v[146:147], v28 offset:49152
    s_waitcnt lgkmcnt(10)
    v_mfma_f32_16x16x32_bf16 v[160:163], v[128:131], v[40:43], v[160:163]
    v_mfma_f32_16x16x32_bf16 v[176:179], v[128:131], v[44:47], v[176:179]
    ds_read_b64_tr_b16 v[148:149], v29 offset:32768
    ds_read_b64_tr_b16 v[150:151], v29 offset:49152
    s_waitcnt lgkmcnt(10)
    v_mfma_f32_16x16x32_bf16 v[164:167], v[132:135], v[40:43], v[164:167]
    v_mfma_f32_16x16x32_bf16 v[180:183], v[132:135], v[44:47], v[180:183]
    ds_read_b64_tr_b16 v[152:153], v30 offset:32768
    ds_read_b64_tr_b16 v[154:155], v30 offset:49152
    s_waitcnt lgkmcnt(10)
    v_mfma_f32_16x16x32_bf16 v[168:171], v[136:139], v[40:43], v[168:171]
    v_mfma_f32_16x16x32_bf16 v[184:187], v[136:139], v[44:47], v[184:187]
    ds_read_b64_tr_b16 v[156:157], v31 offset:32768
    ds_read_b64_tr_b16 v[158:159], v31 offset:49152
    s_waitcnt lgkmcnt(10)
    v_mfma_f32_16x16x32_bf16 v[172:175], v[140:143], v[40:43], v[172:175]
    v_mfma_f32_16x16x32_bf16 v[188:191], v[140:143], v[44:47], v[188:191]
    s_waitcnt lgkmcnt(6)
    v_mfma_f32_16x16x32_bf16 v[160:163], v[144:147], v[48:51], v[160:163]
    v_mfma_f32_16x16x32_bf16 v[176:179], v[144:147], v[52:55], v[176:179]
    s_waitcnt lgkmcnt(4)
    v_mfma_f32_16x16x32_bf16 v[164:167], v[148:151], v[48:51], v[164:167]
    v_mfma_f32_16x16x32_bf16 v[180:183], v[148:151], v[52:55], v[180:183]
    s_waitcnt lgkmcnt(2)
    v_mfma_f32_16x16x32_bf16 v[168:171], v[152:155], v[48:51], v[168:171]
    v_mfma_f32_16x16x32_bf16 v[184:187], v[152:155], v[52:55], v[184:187]
    s_waitcnt lgkmcnt(0)
    v_mfma_f32_16x16x32_bf16 v[172:175], v[156:159], v[48:51], v[172:175]
    v_mfma_f32_16x16x32_bf16 v[188:191], v[156:159], v[52:55], v[188:191]
    v_and_b32 v6, 7, v2
    v_lshlrev_b32 v6, 10, v6
    v_lshrrev_b32 v8, 3, v2
    v_lshl_add_u32 v6, v8, 6, v6
    v_lshl_add_u32 v6, v1, 4, v6
    s_lshl_b32 s39, s33, 15
    s_add_u32 s39, s39, s41
    s_add_u32 s39, s39, 2097152
    v_cvt_pk_bf16_f32 v64, v160, v161
    v_cvt_pk_bf16_f32 v65, v162, v163
    v_cvt_pk_bf16_f32 v66, v164, v165
    v_cvt_pk_bf16_f32 v67, v166, v167
    v_cvt_pk_bf16_f32 v68, v168, v169
    v_cvt_pk_bf16_f32 v69, v170, v171
    v_cvt_pk_bf16_f32 v70, v172, v173
    v_cvt_pk_bf16_f32 v71, v174, v175
    v_mov_b32 v80, v64
    v_mov_b32 v81, v65
    v_mov_b32 v82, v66
    v_mov_b32 v83, v67
    v_mov_b32_dpp v64, v68 row_ror:8 row_mask:0xf bank_mask:0xc
    v_mov_b32_dpp v65, v69 row_ror:8 row_mask:0xf bank_mask:0xc
    v_mov_b32_dpp v66, v70 row_ror:8 row_mask:0xf bank_mask:0xc
    v_mov_b32_dpp v67, v71 row_ror:8 row_mask:0xf bank_mask:0xc
    v_mov_b32_dpp v68, v80 row_ror:8 row_mask:0xf bank_mask:0x3
    v_mov_b32_dpp v69, v81 row_ror:8 row_mask:0xf bank_mask:0x3
    v_mov_b32_dpp v70, v82 row_ror:8 row_mask:0xf bank_mask:0x3
    v_mov_b32_dpp v71, v83 row_ror:8 row_mask:0xf bank_mask:0x3
    buffer_store_dwordx4 v[64:67], v6, s[4:7], s39 offen sc1
    s_add_u32 s39, s39, 8192
    buffer_store_dwordx4 v[68:71], v6, s[4:7], s39 offen sc1
    s_add_u32 s39, s39, 8192
    v_cvt_pk_bf16_f32 v72, v176, v177
    v_cvt_pk_bf16_f32 v73, v178, v179
    v_cvt_pk_bf16_f32 v74, v180, v181
    v_cvt_pk_bf16_f32 v75, v182, v183
    v_cvt_pk_bf16_f32 v76, v184, v185
    v_cvt_pk_bf16_f32 v77, v186, v187
    v_cvt_pk_bf16_f32 v78, v188, v189
    v_cvt_pk_bf16_f32 v79, v190, v191
    v_mov_b32 v80, v72
    v_mov_b32 v81, v73
    v_mov_b32 v82, v74
    v_mov_b32 v83, v75
    v_mov_b32_dpp v72, v76 row_ror:8 row_mask:0xf bank_mask:0xc
    v_mov_b32_dpp v73, v77 row_ror:8 row_mask:0xf bank_mask:0xc
    v_mov_b32_dpp v74, v78 row_ror:8 row_mask:0xf bank_mask:0xc
    v_mov_b32_dpp v75, v79 row_ror:8 row_mask:0xf bank_mask:0xc
    v_mov_b32_dpp v76, v80 row_ror:8 row_mask:0xf bank_mask:0x3
    v_mov_b32_dpp v77, v81 row_ror:8 row_mask:0xf bank_mask:0x3
    v_mov_b32_dpp v78, v82 row_ror:8 row_mask:0xf bank_mask:0x3
    v_mov_b32_dpp v79, v83 row_ror:8 row_mask:0xf bank_mask:0x3
    buffer_store_dwordx4 v[72:75], v6, s[4:7], s39 offen sc1
    s_add_u32 s39, s39, 8192
    buffer_store_dwordx4 v[76:79], v6, s[4:7], s39 offen sc1
    s_add_u32 s39, s39, 8192
    s_waitcnt vmcnt(0)
    s_barrier
    s_setprio 0
    s_cmp_ge_u32 s3, 4
    s_cbranch_scc1 L_amain
    s_cmp_lg_u32 s3, 0
    s_cbranch_scc1 L_fin
    s_setprio 3
    v_and_b32 v6, 31, v0
    v_lshlrev_b32 v7, 4, v6
    v_add_u32 v7, 152192, v7
    ds_read_b128 v[40:43], v7
    v_lshlrev_b32 v6, 3, v6
    s_lshl_b32 s39, s2, 10
    s_add_u32 s39, s39, 328192
    v_cmp_eq_u32 vcc, 0, v1
    s_nop 1
    v_cndmask_b32 v8, v11, v10, vcc
    s_waitcnt lgkmcnt(0)
    v_add_f32 v9, v40, v41
    v_add_f32 v42, v42, v43
    v_add_f32 v9, v9, v42
    v_min_u32 v8, -2, v8
    v_min_u32 v9, -2, v9
    s_mov_b32 exec_hi, 0
    buffer_store_dwordx2 v[8:9], v6, s[4:7], s39 offen sc1
    s_mov_b64 exec, -1
    s_branch L_fin
L_at:
    v_mov_b32 v16, 151664
    s_mov_b32 s29, 1600000
L_wl_24:
    ds_read_b32 v17, v16
    s_sub_u32 s29, s29, 1
    s_cbranch_scc1 L_wl_24_x
    s_waitcnt lgkmcnt(0)
    v_readfirstlane_b32 s28, v17
    s_cmp_ge_u32 s28, 1
    s_nop 2
    s_cbranch_scc1 L_wl_24_x
    s_sleep 1
    s_branch L_wl_24
L_wl_24_x:
    s_waitcnt lgkmcnt(0)
    ds_read_b32 v17, v16 offset:4
    s_waitcnt lgkmcnt(0)
    v_readfirstlane_b32 s63, v17
    s_cmp_lg_u32 s3, 0
    s_nop 2
    s_cbranch_scc1 L_atq_25
    s_and_b32 s52, s45, 15
    s_lshl_b32 s53, s52, 2
    s_add_u32 s53, s53, 64
    v_bfe_u32 v40, v0, 3, 2
    v_add_u32 v41, s53, v40
    v_lshlrev_b32 v41, 7, v41
    v_add_u32 v41, 32768, v41
    s_lshl_b32 s53, s45, 12
    s_add_u32 s53, s53, 66432
    v_mov_b32 v42, s53
    v_cmp_lt_u32 vcc, 31, v0
    s_nop 1
    v_cndmask_b32 v41, v41, v42, vcc
    v_and_b32 v42, 7, v0
    v_lshlrev_b32 v42, 4, v42
    v_lshl_add_u32 v42, v40, 10, v42
    s_lshl_b32 s52, s52, 12
    s_lshr_b32 s53, s45, 4
    s_lshl_b32 s53, s53, 7
    s_add_u32 s52, s52, s53
    s_add_u32 s52, s52, 393216
    v_lshlrev_b32 v43, 4, v0
    v_add_u32 v43, 158080, v43
    s_mov_b32 s29, 200000
L_cf_26:
    buffer_load_dword v49, v41, s[4:7], 0 offen sc1
    s_sub_u32 s29, s29, 1
    s_cbranch_scc1 L_cf_26_x
    s_waitcnt vmcnt(0)
    v_cmp_ne_u32 vcc, s63, v49
    s_nop 3
    s_cbranch_vccz L_cf_26_x
    s_mov_b64 exec, vcc
    s_sleep 4
    s_branch L_cf_26
L_cf_26_x:
    s_mov_b64 exec, -1
    s_waitcnt vmcnt(0)
    v_mov_b32 v48, 151656
    v_mov_b32 v49, 4
    ds_write_b32 v48, v49
    s_mov_b32 exec_hi, 0
    s_mov_b32 s29, 200000
L_poll_27:
    buffer_load_dwordx4 v[44:47], v42, s[4:7], s52 offen sc1
    s_sub_u32 s29, s29, 1
    s_cbranch_scc1 L_poll_27_x
    s_waitcnt vmcnt(0)
    v_max3_u32 v48, v44, v45, v46
    v_max_u32 v48, v48, v47
    v_cmp_eq_u32 vcc, -1, v48
    s_nop 3
    s_cbranch_vccz L_poll_27_x
    s_mov_b64 exec, vcc
    s_sleep 2
    s_branch L_poll_27
L_poll_27_x:
    s_mov_b64 exec, -1
    s_waitcnt vmcnt(0)
    s_mov_b32 exec_hi, 0
    ds_write_b128 v43, v[44:47]
    v_mov_b32 v48, 151652
    v_mov_b32 v49, 1
    ds_write_b32 v48, v49
    s_mov_b64 exec, -1
L_atq_25:
    v_mov_b32 v16, 151652
    s_mov_b32 s29, 1600000
L_wl_28:
    ds_read_b32 v17, v16
    s_sub_u32 s29, s29, 1
    s_cbranch_scc1 L_wl_28_x
    s_waitcnt lgkmcnt(0)
    v_readfirstlane_b32 s28, v17
    s_cmp_ge_u32 s28, 1
    s_nop 2
    s_cbranch_scc1 L_wl_28_x
    s_sleep 2
    s_branch L_wl_28
L_wl_28_x:
    s_waitcnt lgkmcnt(0)
    s_mov_b32 s12, s72
    s_mov_b32 s13, s73
    s_mov_b32 s14, 4718592
    s_mov_b32 s15, 0x20000
    s_and_b32 s33, s2, 31
    s_mul_i32 s36, s33, 147456
    s_mul_i32 s37, s3, 1024
    s_add_u32 s36, s36, s37
    s_add_u32 s34, s36, 0
    s_add_u32 m0, s37, 0
    s_waitcnt vmcnt(15)
    buffer_load_dwordx4 v4, s[12:15], s34 offen offset:0 nt lds
    s_add_u32 s34, s36, 32768
    s_add_u32 m0, s37, 32768
    s_waitcnt vmcnt(15)
    buffer_load_dwordx4 v4, s[12:15], s34 offen offset:0 nt lds
    s_add_u32 s34, s36, 65536
    s_add_u32 m0, s37, 65536
    s_waitcnt vmcnt(15)
    buffer_load_dwordx4 v4, s[12:15], s34 offen offset:0 nt lds
    s_add_u32 s34, s36, 98304
    s_add_u32 m0, s37, 98304
    s_waitcnt vmcnt(15)
    buffer_load_dwordx4 v4, s[12:15], s34 offen offset:0 nt lds
    s_add_u32 s34, s36, 131072
    s_add_u32 m0, s37, 131072
    s_waitcnt vmcnt(15)
    buffer_load_dwordx4 v4, s[12:15], s34 offen offset:0 nt lds
    s_add_u32 s34, s36, 4096
    s_add_u32 m0, s37, 4096
    s_waitcnt vmcnt(15)
    buffer_load_dwordx4 v4, s[12:15], s34 offen offset:0 nt lds
    s_add_u32 s34, s36, 36864
    s_add_u32 m0, s37, 36864
    s_waitcnt vmcnt(15)
    buffer_load_dwordx4 v4, s[12:15], s34 offen offset:0 nt lds
    s_add_u32 s34, s36, 69632
    s_add_u32 m0, s37, 69632
    s_waitcnt vmcnt(15)
    buffer_load_dwordx4 v4, s[12:15], s34 offen offset:0 nt lds
    s_add_u32 s34, s36, 102400
    s_add_u32 m0, s37, 102400
    s_waitcnt vmcnt(15)
    buffer_load_dwordx4 v4, s[12:15], s34 offen offset:0 nt lds
    s_add_u32 s34, s36, 135168
    s_add_u32 m0, s37, 135168
    s_waitcnt vmcnt(15)
    buffer_load_dwordx4 v4, s[12:15], s34 offen offset:0 nt lds
    s_add_u32 s34, s36, 8192
    s_add_u32 m0, s37, 8192
    s_waitcnt vmcnt(15)
    buffer_load_dwordx4 v4, s[12:15], s34 offen offset:0 nt lds
    s_add_u32 s34, s36, 40960
    s_add_u32 m0, s37, 40960
    s_waitcnt vmcnt(15)
    buffer_load_dwordx4 v4, s[12:15], s34 offen offset:0 nt lds
    s_add_u32 s34, s36, 73728
    s_add_u32 m0, s37, 73728
    s_waitcnt vmcnt(15)
    buffer_load_dwordx4 v4, s[12:15], s34 offen offset:0 nt lds
    s_add_u32 s34, s36, 106496
    s_add_u32 m0, s37, 106496
    s_waitcnt vmcnt(15)
    buffer_load_dwordx4 v4, s[12:15], s34 offen offset:0 nt lds
    s_add_u32 s34, s36, 139264
    s_add_u32 m0, s37, 139264
    s_waitcnt vmcnt(15)
    buffer_load_dwordx4 v4, s[12:15], s34 offen offset:0 nt lds
    s_add_u32 s34, s36, 12288
    s_add_u32 m0, s37, 12288
    s_waitcnt vmcnt(15)
    buffer_load_dwordx4 v4, s[12:15], s34 offen offset:0 nt lds
    s_add_u32 s34, s36, 45056
    s_add_u32 m0, s37, 45056
    s_waitcnt vmcnt(15)
    buffer_load_dwordx4 v4, s[12:15], s34 offen offset:0 nt lds
    s_add_u32 s34, s36, 77824
    s_add_u32 m0, s37, 77824
    s_waitcnt vmcnt(15)
    buffer_load_dwordx4 v4, s[12:15], s34 offen offset:0 nt lds
    s_add_u32 s34, s36, 110592
    s_add_u32 m0, s37, 110592
    s_waitcnt vmcnt(15)
    buffer_load_dwordx4 v4, s[12:15], s34 offen offset:0 nt lds
    s_add_u32 s34, s36, 143360
    s_add_u32 m0, s37, 143360
    s_waitcnt vmcnt(15)
    buffer_load_dwordx4 v4, s[12:15], s34 offen offset:0 nt lds
    s_add_u32 s34, s36, 16384
    s_add_u32 m0, s37, 16384
    s_waitcnt vmcnt(15)
    buffer_load_dwordx4 v4, s[12:15], s34 offen offset:0 nt lds
    s_add_u32 s34, s36, 49152
    s_add_u32 m0, s37, 49152
    s_waitcnt vmcnt(15)
    buffer_load_dwordx4 v4, s[12:15], s34 offen offset:0 nt lds
    s_add_u32 s34, s36, 81920
    s_add_u32 m0, s37, 81920
    s_waitcnt vmcnt(15)
    buffer_load_dwordx4 v4, s[12:15], s34 offen offset:0 nt lds
    s_add_u32 s34, s36, 114688
    s_add_u32 m0, s37, 114688
    s_waitcnt vmcnt(15)
    buffer_load_dwordx4 v4, s[12:15], s34 offen offset:0 nt lds
    s_add_u32 s34, s36, 20480
    s_add_u32 m0, s37, 20480
    s_waitcnt vmcnt(15)
    buffer_load_dwordx4 v4, s[12:15], s34 offen offset:0 nt lds
    s_add_u32 s34, s36, 53248
    s_add_u32 m0, s37, 53248
    s_waitcnt vmcnt(15)
    buffer_load_dwordx4 v4, s[12:15], s34 offen offset:0 nt lds
    s_add_u32 s34, s36, 86016
    s_add_u32 m0, s37, 86016
    s_waitcnt vmcnt(15)
    buffer_load_dwordx4 v4, s[12:15], s34 offen offset:0 nt lds
    s_add_u32 s34, s36, 118784
    s_add_u32 m0, s37, 118784
    s_waitcnt vmcnt(15)
    buffer_load_dwordx4 v4, s[12:15], s34 offen offset:0 nt lds
    s_add_u32 s34, s36, 24576
    s_add_u32 m0, s37, 24576
    s_waitcnt vmcnt(15)
    buffer_load_dwordx4 v4, s[12:15], s34 offen offset:0 nt lds
    s_add_u32 s34, s36, 57344
    s_add_u32 m0, s37, 57344
    s_waitcnt vmcnt(15)
    buffer_load_dwordx4 v4, s[12:15], s34 offen offset:0 nt lds
    s_add_u32 s34, s36, 90112
    s_add_u32 m0, s37, 90112
    s_waitcnt vmcnt(15)
    buffer_load_dwordx4 v4, s[12:15], s34 offen offset:0 nt lds
    s_add_u32 s34, s36, 122880
    s_add_u32 m0, s37, 122880
    s_waitcnt vmcnt(15)
    buffer_load_dwordx4 v4, s[12:15], s34 offen offset:0 nt lds
    s_add_u32 s34, s36, 28672
    s_add_u32 m0, s37, 28672
    s_waitcnt vmcnt(15)
    buffer_load_dwordx4 v4, s[12:15], s34 offen offset:0 nt lds
    s_add_u32 s34, s36, 61440
    s_add_u32 m0, s37, 61440
    s_waitcnt vmcnt(15)
    buffer_load_dwordx4 v4, s[12:15], s34 offen offset:0 nt lds
    s_add_u32 s34, s36, 94208
    s_add_u32 m0, s37, 94208
    s_waitcnt vmcnt(15)
    buffer_load_dwordx4 v4, s[12:15], s34 offen offset:0 nt lds
    s_add_u32 s34, s36, 126976
    s_add_u32 m0, s37, 126976
    s_waitcnt vmcnt(15)
    buffer_load_dwordx4 v4, s[12:15], s34 offen offset:0 nt lds
    v_lshrrev_b32 v5, 2, v0
    v_mul_u32_u24 v5, 9216, v5
    v_and_b32 v6, 3, v0
    v_lshl_add_u32 v5, v6, 3, v5
    s_lshl_b32 s38, s3, 5
    s_add_u32 s38, s38, 1024
    v_add_u32 v6, s38, v5
    s_lshl_b32 s38, s3, 8
    v_add_u32 v5, s38, v5
    s_waitcnt vmcnt(0)
    s_waitcnt lgkmcnt(0)
    v_mov_b32 v16, 151616
    v_mov_b32 v17, 1
    s_mov_b64 exec, 1
    ds_add_u32 v16, v17
    s_mov_b64 exec, -1
    v_mov_b32 v16, 151616
    s_mov_b32 s29, 1600000
L_wl_29:
    ds_read_b32 v17, v16
    s_sub_u32 s29, s29, 1
    s_cbranch_scc1 L_wl_29_x
    s_waitcnt lgkmcnt(0)
    v_readfirstlane_b32 s28, v17
    s_cmp_ge_u32 s28, 4
    s_nop 2
    s_cbranch_scc1 L_wl_29_x
    s_branch L_wl_29
L_wl_29_x:
    s_waitcnt lgkmcnt(0)
    ds_read_b64_tr_b16 v[64:65], v5 offset:0
    ds_read_b64_tr_b16 v[66:67], v5 offset:1152
    ds_read_b64_tr_b16 v[68:69], v5 offset:2304
    ds_read_b64_tr_b16 v[70:71], v5 offset:3456
    ds_read_b64_tr_b16 v[72:73], v5 offset:4608
    ds_read_b64_tr_b16 v[74:75], v5 offset:5760
    ds_read_b64_tr_b16 v[76:77], v5 offset:6912
    ds_read_b64_tr_b16 v[78:79], v5 offset:8064
    s_waitcnt lgkmcnt(7)
    ds_read_b64_tr_b16 v[80:81], v5 offset:32
    ds_read_b64_tr_b16 v[82:83], v5 offset:1184
    ds_read_b64_tr_b16 v[84:85], v5 offset:2336
    ds_read_b64_tr_b16 v[86:87], v5 offset:3488
    ds_read_b64_tr_b16 v[88:89], v5 offset:4640
    ds_read_b64_tr_b16 v[90:91], v5 offset:5792
    ds_read_b64_tr_b16 v[92:93], v5 offset:6944
    ds_read_b64_tr_b16 v[94:95], v5 offset:8096
    s_waitcnt lgkmcnt(7)
    ds_read_b64_tr_b16 v[96:97], v5 offset:64
    ds_read_b64_tr_b16 v[98:99], v5 offset:1216
    ds_read_b64_tr_b16 v[100:101], v5 offset:2368
    ds_read_b64_tr_b16 v[102:103], v5 offset:3520
    ds_read_b64_tr_b16 v[104:105], v5 offset:4672
    ds_read_b64_tr_b16 v[106:107], v5 offset:5824
    ds_read_b64_tr_b16 v[108:109], v5 offset:6976
    ds_read_b64_tr_b16 v[110:111], v5 offset:8128
    s_waitcnt lgkmcnt(7)
    ds_read_b64_tr_b16 v[112:113], v5 offset:96
    ds_read_b64_tr_b16 v[114:115], v5 offset:1248
    ds_read_b64_tr_b16 v[116:117], v5 offset:2400
    ds_read_b64_tr_b16 v[118:119], v5 offset:3552
    ds_read_b64_tr_b16 v[120:121], v5 offset:4704
    ds_read_b64_tr_b16 v[122:123], v5 offset:5856
    ds_read_b64_tr_b16 v[124:125], v5 offset:7008
    ds_read_b64_tr_b16 v[126:127], v5 offset:8160
    s_waitcnt lgkmcnt(7)
    ds_read_b64_tr_b16 v[128:129], v5 offset:128
    ds_read_b64_tr_b16 v[130:131], v5 offset:1280
    ds_read_b64_tr_b16 v[132:133], v5 offset:2432
    ds_read_b64_tr_b16 v[134:135], v5 offset:3584
    ds_read_b64_tr_b16 v[136:137], v5 offset:4736
    ds_read_b64_tr_b16 v[138:139], v5 offset:5888
    ds_read_b64_tr_b16 v[140:141], v5 offset:7040
    ds_read_b64_tr_b16 v[142:143], v5 offset:8192
    s_waitcnt lgkmcnt(7)
    ds_read_b64_tr_b16 v[144:145], v5 offset:160
    ds_read_b64_tr_b16 v[146:147], v5 offset:1312
    ds_read_b64_tr_b16 v[148:149], v5 offset:2464
    ds_read_b64_tr_b16 v[150:151], v5 offset:3616
    ds_read_b64_tr_b16 v[152:153], v5 offset:4768
    ds_read_b64_tr_b16 v[154:155], v5 offset:5920
    ds_read_b64_tr_b16 v[156:157], v5 offset:7072
    ds_read_b64_tr_b16 v[158:159], v5 offset:8224
    s_waitcnt lgkmcnt(7)
    ds_read_b64_tr_b16 v[160:161], v5 offset:192
    ds_read_b64_tr_b16 v[162:163], v5 offset:1344
    ds_read_b64_tr_b16 v[164:165], v5 offset:2496
    ds_read_b64_tr_b16 v[166:167], v5 offset:3648
    ds_read_b64_tr_b16 v[168:169], v5 offset:4800
    ds_read_b64_tr_b16 v[170:171], v5 offset:5952
    ds_read_b64_tr_b16 v[172:173], v5 offset:7104
    ds_read_b64_tr_b16 v[174:175], v5 offset:8256
    s_waitcnt lgkmcnt(7)
    ds_read_b64_tr_b16 v[176:177], v5 offset:224
    ds_read_b64_tr_b16 v[178:179], v5 offset:1376
    ds_read_b64_tr_b16 v[180:181], v5 offset:2528
    ds_read_b64_tr_b16 v[182:183], v5 offset:3680
    ds_read_b64_tr_b16 v[184:185], v5 offset:4832
    ds_read_b64_tr_b16 v[186:187], v5 offset:5984
    ds_read_b64_tr_b16 v[188:189], v5 offset:7136
    ds_read_b64_tr_b16 v[190:191], v5 offset:8288
    s_waitcnt lgkmcnt(7)
    ds_read_b64_tr_b16 v[192:193], v6 offset:0
    ds_read_b64_tr_b16 v[194:195], v6 offset:1152
    ds_read_b64_tr_b16 v[196:197], v6 offset:2304
    ds_read_b64_tr_b16 v[198:199], v6 offset:3456
    ds_read_b64_tr_b16 v[200:201], v6 offset:4608
    ds_read_b64_tr_b16 v[202:203], v6 offset:5760
    ds_read_b64_tr_b16 v[204:205], v6 offset:6912
    ds_read_b64_tr_b16 v[206:207], v6 offset:8064
    s_waitcnt lgkmcnt(7)
    s_lshr_b32 s36, s33, 1
    s_lshl_b32 s36, s36, 2
    v_lshrrev_b32 v6, 2, v2
    v_lshlrev_b32 v6, 6, v6
    v_and_b32 v7, 3, v2
    v_add_u32 v6, v6, v7
    v_add_u32 v8, s36, v6
    v_lshlrev_b32 v6, 10, v6
    v_lshl_add_u32 v6, v1, 4, v6
    v_lshl_add_u32 v7, v1, 6, v7
    v_lshlrev_b32 v7, 10, v7
    s_lshl_b32 s36, s36, 10
    s_add_u32 s36, s36, 65536
    s_and_b32 s37, s33, 1
    s_lshl_b32 s40, s37, 3
    s_add_u32 s41, s36, s40
    s_add_u32 s41, s41, 512
    s_lshl_b32 s37, s37, 8
    s_add_u32 s36, s36, s37
    s_mul_i32 s38, s33, 9216
    s_add_u32 s38, s38, 589824
    s_lshl_b32 s39, s3, 8
    s_add_u32 s39, s39, s38
    s_add_u32 s39, s39, 8192
    s_lshl_b32 s40, s3, 11
    s_add_u32 s38, s38, s40
    v_lshlrev_b32 v10, 10, v1
    v_lshl_add_u32 v9, v2, 4, v10
    s_lshl_b32 s43, s3, 16
    s_add_u32 s42, s36, s43
    s_add_u32 s43, s41, s43
    s_lshl_b32 s40, s3, 2
    v_add_u32 v12, s40, v1
    v_mul_u32_u24 v11, 272, v12
    v_lshl_add_u32 v11, v2, 4, v11
    v_add_u32 v11, 151680, v11
    v_lshlrev_b32 v12, 3, v12
    v_add_u32 v12, 156032, v12
    v_mul_u32_u24 v13, 272, v2
    v_lshl_add_u32 v13, v1, 4, v13
    v_add_u32 v13, 151680, v13
    v_and_b32 v14, 3, v2
    v_lshl_add_u32 v14, v1, 2, v14
    v_lshlrev_b32 v14, 3, v14
    v_add_u32 v14, 156032, v14
    v_lshlrev_b32 v8, 10, v8
    v_add_u32 v8, 66432, v8
    s_mov_b32 s29, 200000
L_cf_30:
    buffer_load_dword v17, v8, s[4:7], 0 offen sc1
    s_sub_u32 s29, s29, 1
    s_cbranch_scc1 L_cf_30_x
    s_waitcnt vmcnt(0)
    v_cmp_ne_u32 vcc, s63, v17
    s_nop 3
    s_cbranch_vccz L_cf_30_x
    s_mov_b64 exec, vcc
    s_sleep 4
    s_branch L_cf_30
L_cf_30_x:
    s_mov_b64 exec, -1
    s_waitcnt vmcnt(0)
    v_mov_b32 v16, 151676
    s_mov_b32 s29, 1600000
L_wl_31:
    ds_read_b32 v17, v16
    s_sub_u32 s29, s29, 1
    s_cbranch_scc1 L_wl_31_x
    s_waitcnt lgkmcnt(0)
    v_readfirstlane_b32 s28, v17
    s_cmp_ge_u32 s28, 4
    s_nop 2
    s_cbranch_scc1 L_wl_31_x
    s_sleep 1
    s_branch L_wl_31
L_wl_31_x:
    s_waitcnt lgkmcnt(0)
    s_mov_b32 s29, 200000
L_fp_32:
    buffer_load_dwordx4 v[44:47], v9, s[4:7], s42 offen sc1
    buffer_load_dwordx2 v[48:49], v10, s[4:7], s43 offen sc1
    s_sub_u32 s29, s29, 1
    s_cbranch_scc1 L_fp_32_x
    s_waitcnt vmcnt(0)
    v_max3_u32 v16, v44, v45, v46
    v_max3_u32 v16, v16, v47, v48
    v_max_u32 v16, v16, v49
    v_cmp_eq_u32 vcc, -1, v16
    s_nop 3
    s_cbranch_vccz L_fp_32_x
    s_mov_b64 exec, vcc
    s_sleep 1
    s_branch L_fp_32
L_fp_32_x:
    s_mov_b64 exec, -1
    ds_write_b128 v11, v[44:47]
    ds_write_b64 v12, v[48:49]
    s_waitcnt lgkmcnt(0)
    v_mov_b32 v16, 151620
    v_mov_b32 v17, 1
    s_mov_b64 exec, 1
    ds_add_u32 v16, v17
    s_mov_b64 exec, -1
    v_mov_b32 v16, 151620
    s_mov_b32 s29, 1600000
L_wl_33:
    ds_read_b32 v17, v16
    s_sub_u32 s29, s29, 1
    s_cbranch_scc1 L_wl_33_x
    s_waitcnt lgkmcnt(0)
    v_readfirstlane_b32 s28, v17
    s_cmp_ge_u32 s28, 4
    s_nop 2
    s_cbranch_scc1 L_wl_33_x
    s_branch L_wl_33
L_wl_33_x:
    s_waitcnt lgkmcnt(0)
    ds_read_b128 v[24:27], v13 offset:0
    ds_read_b128 v[28:31], v13 offset:64
    ds_read_b128 v[32:35], v13 offset:128
    ds_read_b128 v[36:39], v13 offset:192
    ds_read_b64 v[40:41], v14
    s_waitcnt lgkmcnt(0)
    v_mfma_f32_16x16x32_bf16 v[208:211], v[24:27], v[64:67], 0
    v_mfma_f32_16x16x32_bf16 v[208:211], v[28:31], v[68:71], v[208:211]
    v_mfma_f32_16x16x32_bf16 v[208:211], v[32:35], v[72:75], v[208:211]
    v_mfma_f32_16x16x32_bf16 v[208:211], v[36:39], v[76:79], v[208:211]
    v_max_f32_dpp v16, v40, v40 quad_perm:[1,0,3,2] row_mask:0xf bank_mask:0xf
    s_nop 1
    v_max_f32_dpp v16, v16, v16 quad_perm:[2,3,0,1] row_mask:0xf bank_mask:0xf
    v_sub_f32 v17, v40, v16
    v_exp_f32 v17, v17
    s_nop 0
    v_mul_f32 v18, v17, v41
    v_mfma_f32_16x16x32_bf16 v[212:215], v[24:27], v[80:83], 0
    v_mfma_f32_16x16x32_bf16 v[212:215], v[28:31], v[84:87], v[212:215]
    v_mfma_f32_16x16x32_bf16 v[212:215], v[32:35], v[88:91], v[212:215]
    v_mfma_f32_16x16x32_bf16 v[212:215], v[36:39], v[92:95], v[212:215]
    v_add_f32_dpp v18, v18, v18 quad_perm:[1,0,3,2] row_mask:0xf bank_mask:0xf
    s_nop 1
    v_add_f32_dpp v18, v18, v18 quad_perm:[2,3,0,1] row_mask:0xf bank_mask:0xf
    v_rcp_f32 v18, v18
    s_nop 0
    v_mul_f32 v17, v17, v18
    v_mfma_f32_16x16x32_bf16 v[216:219], v[24:27], v[96:99], 0
    v_mfma_f32_16x16x32_bf16 v[216:219], v[28:31], v[100:103], v[216:219]
    v_mfma_f32_16x16x32_bf16 v[216:219], v[32:35], v[104:107], v[216:219]
    v_mfma_f32_16x16x32_bf16 v[216:219], v[36:39], v[108:111], v[216:219]
    v_mov_b32_dpp v48, v17 quad_perm:[0,0,0,0] row_mask:0xf bank_mask:0xf
    v_mov_b32_dpp v49, v17 quad_perm:[1,1,1,1] row_mask:0xf bank_mask:0xf
    v_mov_b32_dpp v50, v17 quad_perm:[2,2,2,2] row_mask:0xf bank_mask:0xf
    v_mov_b32_dpp v51, v17 quad_perm:[3,3,3,3] row_mask:0xf bank_mask:0xf
    v_lshlrev_b32 v16, 2, v0
    v_mfma_f32_16x16x32_bf16 v[220:223], v[24:27], v[112:115], 0
    v_mfma_f32_16x16x32_bf16 v[220:223], v[28:31], v[116:119], v[220:223]
    v_mfma_f32_16x16x32_bf16 v[220:223], v[32:35], v[120:123], v[220:223]
    v_mfma_f32_16x16x32_bf16 v[220:223], v[36:39], v[124:127], v[220:223]
    v_mul_f32 v52, v48, v208
    v_fmac_f32 v52, v49, v209
    v_fmac_f32 v52, v50, v210
    v_fmac_f32 v52, v51, v211
    v_min_u32 v52, -2, v52
    v_mul_f32 v53, v48, v212
    v_fmac_f32 v53, v49, v213
    v_fmac_f32 v53, v50, v214
    v_fmac_f32 v53, v51, v215
    v_min_u32 v53, -2, v53
    v_mfma_f32_16x16x32_bf16 v[224:227], v[24:27], v[128:131], 0
    v_mfma_f32_16x16x32_bf16 v[224:227], v[28:31], v[132:135], v[224:227]
    v_mfma_f32_16x16x32_bf16 v[224:227], v[32:35], v[136:139], v[224:227]
    v_mfma_f32_16x16x32_bf16 v[224:227], v[36:39], v[140:143], v[224:227]
    v_mul_f32 v54, v48, v216
    v_fmac_f32 v54, v49, v217
    v_fmac_f32 v54, v50, v218
    v_fmac_f32 v54, v51, v219
    v_min_u32 v54, -2, v54
    v_mul_f32 v55, v48, v220
    v_fmac_f32 v55, v49, v221
    v_fmac_f32 v55, v50, v222
    v_fmac_f32 v55, v51, v223
    v_min_u32 v55, -2, v55
    buffer_store_dwordx4 v[52:55], v4, s[4:7], s38 offen sc1
    v_mfma_f32_16x16x32_bf16 v[228:231], v[24:27], v[144:147], 0
    v_mfma_f32_16x16x32_bf16 v[228:231], v[28:31], v[148:151], v[228:231]
    v_mfma_f32_16x16x32_bf16 v[228:231], v[32:35], v[152:155], v[228:231]
    v_mfma_f32_16x16x32_bf16 v[228:231], v[36:39], v[156:159], v[228:231]
    v_mul_f32 v56, v48, v224
    v_fmac_f32 v56, v49, v225
    v_fmac_f32 v56, v50, v226
    v_fmac_f32 v56, v51, v227
    v_min_u32 v56, -2, v56
    v_mfma_f32_16x16x32_bf16 v[232:235], v[24:27], v[160:163], 0
    v_mfma_f32_16x16x32_bf16 v[232:235], v[28:31], v[164:167], v[232:235]
    v_mfma_f32_16x16x32_bf16 v[232:235], v[32:35], v[168:171], v[232:235]
    v_mfma_f32_16x16x32_bf16 v[232:235], v[36:39], v[172:175], v[232:235]
    v_mul_f32 v57, v48, v228
    v_fmac_f32 v57, v49, v229
    v_fmac_f32 v57, v50, v230
    v_fmac_f32 v57, v51, v231
    v_min_u32 v57, -2, v57
    v_mfma_f32_16x16x32_bf16 v[236:239], v[24:27], v[176:179], 0
    v_mfma_f32_16x16x32_bf16 v[236:239], v[28:31], v[180:183], v[236:239]
    v_mfma_f32_16x16x32_bf16 v[236:239], v[32:35], v[184:187], v[236:239]
    v_mfma_f32_16x16x32_bf16 v[236:239], v[36:39], v[188:191], v[236:239]
    v_mul_f32 v58, v48, v232
    v_fmac_f32 v58, v49, v233
    v_fmac_f32 v58, v50, v234
    v_fmac_f32 v58, v51, v235
    v_min_u32 v58, -2, v58
    v_mfma_f32_16x16x32_bf16 v[240:243], v[24:27], v[192:195], 0
    v_mfma_f32_16x16x32_bf16 v[240:243], v[28:31], v[196:199], v[240:243]
    v_mfma_f32_16x16x32_bf16 v[240:243], v[32:35], v[200:203], v[240:243]
    v_mfma_f32_16x16x32_bf16 v[240:243], v[36:39], v[204:207], v[240:243]
    v_mul_f32 v59, v48, v236
    v_fmac_f32 v59, v49, v237
    v_fmac_f32 v59, v50, v238
    v_fmac_f32 v59, v51, v239
    v_min_u32 v59, -2, v59
    buffer_store_dwordx4 v[56:59], v4, s[4:7], s38 offen offset:1024 sc1
    s_nop 1
    v_mul_f32 v60, v48, v240
    v_fmac_f32 v60, v49, v241
    v_fmac_f32 v60, v50, v242
    v_fmac_f32 v60, v51, v243
    v_min_u32 v60, -2, v60
    buffer_store_dword v60, v16, s[4:7], s39 offen sc1
    s_branch L_fin
L_bh1:
    s_cmp_lt_u32 s2, 160
    s_cbranch_scc1 L_t3a_34
    s_cmp_lg_u32 s3, 0
    s_cbranch_scc1 L_fin
    v_mov_b32 v16, 151664
    s_mov_b32 s29, 1600000
L_wl_35:
    ds_read_b32 v17, v16
    s_sub_u32 s29, s29, 1
    s_cbranch_scc1 L_wl_35_x
    s_waitcnt lgkmcnt(0)
    v_readfirstlane_b32 s28, v17
    s_cmp_ge_u32 s28, 1
    s_nop 2
    s_cbranch_scc1 L_wl_35_x
    s_sleep 1
    s_branch L_wl_35
L_wl_35_x:
    s_waitcnt lgkmcnt(0)
    ds_read_b32 v17, v16 offset:4
    s_waitcnt lgkmcnt(0)
    v_readfirstlane_b32 s63, v17
    s_and_b32 s52, s45, 15
    s_lshl_b32 s53, s52, 2
    s_add_u32 s53, s53, 64
    v_bfe_u32 v40, v0, 3, 2
    v_add_u32 v41, s53, v40
    v_lshlrev_b32 v41, 7, v41
    v_add_u32 v41, 32768, v41
    s_lshl_b32 s53, s45, 12
    s_add_u32 s53, s53, 66432
    v_mov_b32 v42, s53
    v_cmp_lt_u32 vcc, 31, v0
    s_nop 1
    v_cndmask_b32 v41, v41, v42, vcc
    v_and_b32 v42, 7, v0
    v_lshlrev_b32 v42, 4, v42
    v_lshl_add_u32 v42, v40, 10, v42
    s_lshl_b32 s52, s52, 12
    s_lshr_b32 s53, s45, 4
    s_lshl_b32 s53, s53, 7
    s_add_u32 s52, s52, s53
    s_add_u32 s52, s52, 393216
    v_lshlrev_b32 v43, 4, v0
    v_add_u32 v43, 158080, v43
    s_mov_b32 s29, 200000
L_cf_36:
    buffer_load_dword v49, v41, s[4:7], 0 offen sc1
    s_sub_u32 s29, s29, 1
    s_cbranch_scc1 L_cf_36_x
    s_waitcnt vmcnt(0)
    v_cmp_ne_u32 vcc, s63, v49
    s_nop 3
    s_cbranch_vccz L_cf_36_x
    s_mov_b64 exec, vcc
    s_sleep 4
    s_branch L_cf_36
L_cf_36_x:
    s_mov_b64 exec, -1
    s_waitcnt vmcnt(0)
    v_mov_b32 v48, 151656
    v_mov_b32 v49, 4
    ds_write_b32 v48, v49
    s_mov_b32 exec_hi, 0
    s_mov_b32 s29, 200000
L_poll_37:
    buffer_load_dwordx4 v[44:47], v42, s[4:7], s52 offen sc1
    s_sub_u32 s29, s29, 1
    s_cbranch_scc1 L_poll_37_x
    s_waitcnt vmcnt(0)
    v_max3_u32 v48, v44, v45, v46
    v_max_u32 v48, v48, v47
    v_cmp_eq_u32 vcc, -1, v48
    s_nop 3
    s_cbranch_vccz L_poll_37_x
    s_mov_b64 exec, vcc
    s_sleep 2
    s_branch L_poll_37
L_poll_37_x:
    s_mov_b64 exec, -1
    s_waitcnt vmcnt(0)
    s_mov_b32 exec_hi, 0
    ds_write_b128 v43, v[44:47]
    v_mov_b32 v48, 151652
    v_mov_b32 v49, 1
    ds_write_b32 v48, v49
    s_mov_b64 exec, -1
    s_branch L_fin
L_t3a_34:
    s_mov_b32 s12, s80
    s_mov_b32 s13, s81
    s_mov_b32 s14, 4194304
    s_mov_b32 s15, 0x20000
    s_sub_u32 s36, s2, 128
    s_lshl_b32 s37, s36, 8
    s_lshl_b32 s38, s3, 18
    s_add_u32 s37, s37, s38
    s_lshl_b32 s35, s3, 15
    v_xor_b32 v5, v1, v2
    v_lshlrev_b32 v5, 4, v5
    v_lshl_add_u32 v8, v1, 13, v5
    v_xor_b32 v9, 64, v8
    v_xor_b32 v10, 0x80, v8
    v_xor_b32 v11, 0xc0, v8
    s_add_u32 s34, s37, 0
    s_add_u32 m0, s35, 0
    s_waitcnt vmcnt(31)
    buffer_load_dwordx4 v8, s[12:15], s34 offen offset:0 nt lds
    s_add_u32 s34, s37, 32768
    s_add_u32 m0, s35, 1024
    s_waitcnt vmcnt(31)
    buffer_load_dwordx4 v8, s[12:15], s34 offen offset:0 nt lds
    s_add_u32 s34, s37, 65536
    s_add_u32 m0, s35, 8192
    s_waitcnt vmcnt(31)
    buffer_load_dwordx4 v8, s[12:15], s34 offen offset:0 nt lds
    s_add_u32 s34, s37, 98304
    s_add_u32 m0, s35, 9216
    s_waitcnt vmcnt(31)
    buffer_load_dwordx4 v8, s[12:15], s34 offen offset:0 nt lds
    s_add_u32 s34, s37, 131072
    s_add_u32 m0, s35, 16384
    s_waitcnt vmcnt(31)
    buffer_load_dwordx4 v8, s[12:15], s34 offen offset:0 nt lds
    s_add_u32 s34, s37, 163840
    s_add_u32 m0, s35, 17408
    s_waitcnt vmcnt(31)
    buffer_load_dwordx4 v8, s[12:15], s34 offen offset:0 nt lds
    s_add_u32 s34, s37, 196608
    s_add_u32 m0, s35, 24576
    s_waitcnt vmcnt(31)
    buffer_load_dwordx4 v8, s[12:15], s34 offen offset:0 nt lds
    s_add_u32 s34, s37, 229376
    s_add_u32 m0, s35, 25600
    s_waitcnt vmcnt(31)
    buffer_load_dwordx4 v8, s[12:15], s34 offen offset:0 nt lds
    s_add_u32 s34, s37, 1048576
    s_add_u32 m0, s35, 2048
    s_waitcnt vmcnt(31)
    buffer_load_dwordx4 v9, s[12:15], s34 offen offset:0 nt lds
    s_add_u32 s34, s37, 1081344
    s_add_u32 m0, s35, 3072
    s_waitcnt vmcnt(31)
    buffer_load_dwordx4 v9, s[12:15], s34 offen offset:0 nt lds
    s_add_u32 s34, s37, 1114112
    s_add_u32 m0, s35, 10240
    s_waitcnt vmcnt(31)
    buffer_load_dwordx4 v9, s[12:15], s34 offen offset:0 nt lds
    s_add_u32 s34, s37, 1146880
    s_add_u32 m0, s35, 11264
    s_waitcnt vmcnt(31)
    buffer_load_dwordx4 v9, s[12:15], s34 offen offset:0 nt lds
    s_add_u32 s34, s37, 1179648
    s_add_u32 m0, s35, 18432
    s_waitcnt vmcnt(31)
    buffer_load_dwordx4 v9, s[12:15], s34 offen offset:0 nt lds
    s_add_u32 s34, s37, 1212416
    s_add_u32 m0, s35, 19456
    s_waitcnt vmcnt(31)
    buffer_load_dwordx4 v9, s[12:15], s34 offen offset:0 nt lds
    s_add_u32 s34, s37, 1245184
    s_add_u32 m0, s35, 26624
    s_waitcnt vmcnt(31)
    buffer_load_dwordx4 v9, s[12:15], s34 offen offset:0 nt lds
    s_add_u32 s34, s37, 1277952
    s_add_u32 m0, s35, 27648
    s_waitcnt vmcnt(31)
    buffer_load_dwordx4 v9, s[12:15], s34 offen offset:0 nt lds
    s_add_u32 s34, s37, 2097152
    s_add_u32 m0, s35, 4096
    s_waitcnt vmcnt(31)
    buffer_load_dwordx4 v10, s[12:15], s34 offen offset:0 nt lds
    s_add_u32 s34, s37, 2129920
    s_add_u32 m0, s35, 5120
    s_waitcnt vmcnt(31)
    buffer_load_dwordx4 v10, s[12:15], s34 offen offset:0 nt lds
    s_add_u32 s34, s37, 2162688
    s_add_u32 m0, s35, 12288
    s_waitcnt vmcnt(31)
    buffer_load_dwordx4 v10, s[12:15], s34 offen offset:0 nt lds
    s_add_u32 s34, s37, 2195456
    s_add_u32 m0, s35, 13312
    s_waitcnt vmcnt(31)
    buffer_load_dwordx4 v10, s[12:15], s34 offen offset:0 nt lds
    s_add_u32 s34, s37, 2228224
    s_add_u32 m0, s35, 20480
    s_waitcnt vmcnt(31)
    buffer_load_dwordx4 v10, s[12:15], s34 offen offset:0 nt lds
    s_add_u32 s34, s37, 2260992
    s_add_u32 m0, s35, 21504
    s_waitcnt vmcnt(31)
    buffer_load_dwordx4 v10, s[12:15], s34 offen offset:0 nt lds
    s_add_u32 s34, s37, 2293760
    s_add_u32 m0, s35, 28672
    s_waitcnt vmcnt(31)
    buffer_load_dwordx4 v10, s[12:15], s34 offen offset:0 nt lds
    s_add_u32 s34, s37, 2326528
    s_add_u32 m0, s35, 29696
    s_waitcnt vmcnt(31)
    buffer_load_dwordx4 v10, s[12:15], s34 offen offset:0 nt lds
    s_add_u32 s34, s37, 3145728
    s_add_u32 m0, s35, 6144
    s_waitcnt vmcnt(31)
    buffer_load_dwordx4 v11, s[12:15], s34 offen offset:0 nt lds
    s_add_u32 s34, s37, 3178496
    s_add_u32 m0, s35, 7168
    s_waitcnt vmcnt(31)
    buffer_load_dwordx4 v11, s[12:15], s34 offen offset:0 nt lds
    s_add_u32 s34, s37, 3211264
    s_add_u32 m0, s35, 14336
    s_waitcnt vmcnt(31)
    buffer_load_dwordx4 v11, s[12:15], s34 offen offset:0 nt lds
    s_add_u32 s34, s37, 3244032
    s_add_u32 m0, s35, 15360
    s_waitcnt vmcnt(31)
    buffer_load_dwordx4 v11, s[12:15], s34 offen offset:0 nt lds
    s_add_u32 s34, s37, 3276800
    s_add_u32 m0, s35, 22528
    s_waitcnt vmcnt(31)
    buffer_load_dwordx4 v11, s[12:15], s34 offen offset:0 nt lds
    s_add_u32 s34, s37, 3309568
    s_add_u32 m0, s35, 23552
    s_waitcnt vmcnt(31)
    buffer_load_dwordx4 v11, s[12:15], s34 offen offset:0 nt lds
    s_add_u32 s34, s37, 3342336
    s_add_u32 m0, s35, 30720
    s_waitcnt vmcnt(31)
    buffer_load_dwordx4 v11, s[12:15], s34 offen offset:0 nt lds
    s_add_u32 s34, s37, 3375104
    s_add_u32 m0, s35, 31744
    s_waitcnt vmcnt(31)
    buffer_load_dwordx4 v11, s[12:15], s34 offen offset:0 nt lds
    v_lshrrev_b32 v6, 2, v2
    v_lshlrev_b32 v21, 3, v6
    v_and_b32 v7, 3, v2
    v_add_u32 v21, v21, v7
    v_lshl_add_u32 v12, v21, 8, v5
    v_add_u32 v12, s35, v12
    v_xor_b32 v13, 64, v12
    v_xor_b32 v14, 0x80, v12
    v_xor_b32 v15, 0xc0, v12
    v_lshlrev_b32 v18, 7, v7
    v_lshl_add_u32 v18, v1, 4, v18
    s_lshl_b32 s39, s36, 11
    s_add_u32 s39, s39, 327680
    v_lshlrev_b32 v19, 9, v7
    v_lshl_add_u32 v19, v6, 6, v19
    v_lshl_add_u32 v19, v1, 4, v19
    v_cmp_eq_u32 s[42:43], 1, v6
    v_cmp_eq_u32 s[24:25], 2, v6
    v_cmp_eq_u32 s[26:27], 3, v6
    s_lshl_b32 s40, s36, 12
    s_lshr_b32 s41, s3, 1
    s_lshl_b32 s41, s41, 11
    s_add_u32 s40, s40, s41
    s_and_b32 s41, s3, 1
    s_lshl_b32 s41, s41, 8
    s_add_u32 s40, s40, s41
    s_add_u32 s40, s40, 458752
    s_lshl_b32 s41, s36, 1
    v_and_b32 v20, 1, v0
    v_add_u32 v20, s41, v20
    s_cmp_lg_u32 s3, 0
    s_cbranch_scc1 L_gate_38
    v_mov_b32 v16, 151656
    v_mov_b32 v17, 0
    ds_write_b32 v16, v17
L_gate_38:
    v_lshlrev_b32 v20, 7, v20
    v_add_u32 v20, 32768, v20
    v_mov_b32 v16, 151664
    s_mov_b32 s29, 1600000
L_wl_39:
    ds_read_b32 v17, v16
    s_sub_u32 s29, s29, 1
    s_cbranch_scc1 L_wl_39_x
    s_waitcnt lgkmcnt(0)
    v_readfirstlane_b32 s28, v17
    s_cmp_ge_u32 s28, 1
    s_nop 2
    s_cbranch_scc1 L_wl_39_x
    s_sleep 1
    s_branch L_wl_39
L_wl_39_x:
    s_waitcnt lgkmcnt(0)
    ds_read_b32 v17, v16 offset:4
    s_waitcnt lgkmcnt(0)
    v_readfirstlane_b32 s63, v17
    s_mov_b32 s29, 200000
L_cf_40:
    buffer_load_dword v17, v20, s[4:7], 0 offen sc1
    s_sub_u32 s29, s29, 1
    s_nop 0
    s_cbranch_scc1 L_cf_40_x
    s_waitcnt vmcnt(0)
    v_cmp_ne_u32 vcc, s63, v17
    s_nop 3
    s_cbranch_vccz L_cf_40_x
    s_mov_b64 exec, vcc
    s_sleep 4
    s_branch L_cf_40
L_cf_40_x:
    s_mov_b64 exec, -1
    s_waitcnt vmcnt(0)
    s_waitcnt vmcnt(0)
    ds_read_b128 v[64:67], v12 offset:0
    ds_read_b128 v[68:71], v13 offset:0
    ds_read_b128 v[72:75], v14 offset:0
    ds_read_b128 v[76:79], v15 offset:0
    ds_read_b128 v[80:83], v12 offset:1024
    ds_read_b128 v[84:87], v13 offset:1024
    ds_read_b128 v[88:91], v14 offset:1024
    ds_read_b128 v[92:95], v15 offset:1024
    ds_read_b128 v[96:99], v12 offset:8192
    ds_read_b128 v[100:103], v13 offset:8192
    ds_read_b128 v[104:107], v14 offset:8192
    ds_read_b128 v[108:111], v15 offset:8192
    s_waitcnt lgkmcnt(8)
    ds_read_b128 v[112:115], v12 offset:9216
    ds_read_b128 v[116:119], v13 offset:9216
    ds_read_b128 v[120:123], v14 offset:9216
    ds_read_b128 v[124:127], v15 offset:9216
    s_waitcnt lgkmcnt(8)
    ds_read_b128 v[128:131], v12 offset:16384
    ds_read_b128 v[132:135], v13 offset:16384
    ds_read_b128 v[136:139], v14 offset:16384
    ds_read_b128 v[140:143], v15 offset:16384
    s_waitcnt lgkmcnt(8)
    ds_read_b128 v[144:147], v12 offset:17408
    ds_read_b128 v[148:151], v13 offset:17408
    ds_read_b128 v[152:155], v14 offset:17408
    ds_read_b128 v[156:159], v15 offset:17408
    s_waitcnt lgkmcnt(8)
    ds_read_b128 v[160:163], v12 offset:24576
    ds_read_b128 v[164:167], v13 offset:24576
    ds_read_b128 v[168:171], v14 offset:24576
    ds_read_b128 v[172:175], v15 offset:24576
    s_waitcnt lgkmcnt(8)
    ds_read_b128 v[176:179], v12 offset:25600
    ds_read_b128 v[180:183], v13 offset:25600
    ds_read_b128 v[184:187], v14 offset:25600
    ds_read_b128 v[188:191], v15 offset:25600
    s_waitcnt lgkmcnt(8)
    s_mov_b32 s29, 200000
L_fp_41:
    buffer_load_dwordx4 v[24:27], v18, s[4:7], s39 offen offset:0 sc1
    buffer_load_dwordx4 v[28:31], v18, s[4:7], s39 offen offset:64 sc1
    buffer_load_dwordx4 v[32:35], v18, s[4:7], s39 offen offset:1024 sc1
    buffer_load_dwordx4 v[36:39], v18, s[4:7], s39 offen offset:1088 sc1
    s_sub_u32 s29, s29, 1
    s_cbranch_scc1 L_fp_41_x
    s_waitcnt vmcnt(0)
    v_max3_u32 v16, v24, v25, v26
    v_max3_u32 v16, v16, v27, v28
    v_max3_u32 v16, v16, v29, v30
    v_max3_u32 v16, v16, v31, v32
    v_max3_u32 v16, v16, v33, v34
    v_max3_u32 v16, v16, v35, v36
    v_max3_u32 v16, v16, v37, v38
    v_max_u32 v16, v16, v39
    v_cmp_eq_u32 vcc, -1, v16
    s_nop 3
    s_cbranch_vccz L_fp_41_x
    s_mov_b64 exec, vcc
    s_sleep 2
    s_branch L_fp_41
L_fp_41_x:
    s_mov_b64 exec, -1
    s_waitcnt lgkmcnt(0)
    v_mfma_f32_16x16x32_bf16 v[192:195], v[64:67], v[24:27], 0
    v_mfma_f32_16x16x32_bf16 v[192:195], v[68:71], v[28:31], v[192:195]
    v_mfma_f32_16x16x32_bf16 v[192:195], v[72:75], v[32:35], v[192:195]
    v_mfma_f32_16x16x32_bf16 v[192:195], v[76:79], v[36:39], v[192:195]
    v_mfma_f32_16x16x32_bf16 v[196:199], v[80:83], v[24:27], 0
    v_mfma_f32_16x16x32_bf16 v[196:199], v[84:87], v[28:31], v[196:199]
    v_mfma_f32_16x16x32_bf16 v[196:199], v[88:91], v[32:35], v[196:199]
    v_mfma_f32_16x16x32_bf16 v[196:199], v[92:95], v[36:39], v[196:199]
    v_mfma_f32_16x16x32_bf16 v[200:203], v[96:99], v[24:27], 0
    v_mfma_f32_16x16x32_bf16 v[200:203], v[100:103], v[28:31], v[200:203]
    v_mfma_f32_16x16x32_bf16 v[200:203], v[104:107], v[32:35], v[200:203]
    v_mfma_f32_16x16x32_bf16 v[200:203], v[108:111], v[36:39], v[200:203]
    v_mfma_f32_16x16x32_bf16 v[204:207], v[112:115], v[24:27], 0
    v_mfma_f32_16x16x32_bf16 v[204:207], v[116:119], v[28:31], v[204:207]
    v_mfma_f32_16x16x32_bf16 v[204:207], v[120:123], v[32:35], v[204:207]
    v_mfma_f32_16x16x32_bf16 v[204:207], v[124:127], v[36:39], v[204:207]
    v_mfma_f32_16x16x32_bf16 v[208:211], v[128:131], v[24:27], 0
    v_mfma_f32_16x16x32_bf16 v[208:211], v[132:135], v[28:31], v[208:211]
    v_mfma_f32_16x16x32_bf16 v[208:211], v[136:139], v[32:35], v[208:211]
    v_mfma_f32_16x16x32_bf16 v[208:211], v[140:143], v[36:39], v[208:211]
    v_mfma_f32_16x16x32_bf16 v[212:215], v[144:147], v[24:27], 0
    v_mfma_f32_16x16x32_bf16 v[212:215], v[148:151], v[28:31], v[212:215]
    v_mfma_f32_16x16x32_bf16 v[212:215], v[152:155], v[32:35], v[212:215]
    v_mfma_f32_16x16x32_bf16 v[212:215], v[156:159], v[36:39], v[212:215]
    v_mfma_f32_16x16x32_bf16 v[216:219], v[160:163], v[24:27], 0
    v_mfma_f32_16x16x32_bf16 v[216:219], v[164:167], v[28:31], v[216:219]
    v_mfma_f32_16x16x32_bf16 v[216:219], v[168:171], v[32:35], v[216:219]
    v_mfma_f32_16x16x32_bf16 v[216:219], v[172:175], v[36:39], v[216:219]
    v_mfma_f32_16x16x32_bf16 v[220:223], v[176:179], v[24:27], 0
    v_mfma_f32_16x16x32_bf16 v[220:223], v[180:183], v[28:31], v[220:223]
    v_mfma_f32_16x16x32_bf16 v[220:223], v[184:187], v[32:35], v[220:223]
    v_mfma_f32_16x16x32_bf16 v[220:223], v[188:191], v[36:39], v[220:223]
    v_cvt_pk_bf16_f32 v40, v192, v193
    v_cvt_pk_bf16_f32 v41, v194, v195
    v_cvt_pk_bf16_f32 v42, v196, v197
    v_cvt_pk_bf16_f32 v43, v198, v199
    v_cvt_pk_bf16_f32 v44, v200, v201
    v_cvt_pk_bf16_f32 v45, v202, v203
    v_cvt_pk_bf16_f32 v46, v204, v205
    v_cvt_pk_bf16_f32 v47, v206, v207
    v_cvt_pk_bf16_f32 v48, v208, v209
    v_cvt_pk_bf16_f32 v49, v210, v211
    v_cvt_pk_bf16_f32 v50, v212, v213
    v_cvt_pk_bf16_f32 v51, v214, v215
    v_cvt_pk_bf16_f32 v52, v216, v217
    v_cvt_pk_bf16_f32 v53, v218, v219
    v_cvt_pk_bf16_f32 v54, v220, v221
    v_cvt_pk_bf16_f32 v55, v222, v223
    v_cndmask_b32 v40, v40, v44, s[42:43]
    v_cndmask_b32 v41, v41, v45, s[42:43]
    v_cndmask_b32 v42, v42, v46, s[42:43]
    v_cndmask_b32 v43, v43, v47, s[42:43]
    v_cndmask_b32 v40, v40, v48, s[24:25]
    v_cndmask_b32 v41, v41, v49, s[24:25]
    v_cndmask_b32 v42, v42, v50, s[24:25]
    v_cndmask_b32 v43, v43, v51, s[24:25]
    v_cndmask_b32 v40, v40, v52, s[26:27]
    v_cndmask_b32 v41, v41, v53, s[26:27]
    v_cndmask_b32 v42, v42, v54, s[26:27]
    v_cndmask_b32 v43, v43, v55, s[26:27]
    v_min_u32 v40, -2, v40
    v_min_u32 v41, -2, v41
    v_min_u32 v42, -2, v42
    v_min_u32 v43, -2, v43
    buffer_store_dwordx4 v[40:43], v19, s[4:7], s40 offen sc1
    s_cmp_lg_u32 s3, 0
    s_cbranch_scc1 L_gate_42
    v_mov_b32 v16, 151656
    v_mov_b32 v17, 4
    ds_write_b32 v16, v17
L_gate_42:
    s_branch L_fin
L_bh2:
    s_mov_b32 s12, s82
    s_mov_b32 s13, s83
    s_mov_b32 s14, 4194304
    s_mov_b32 s15, 0x20000
    s_mov_b32 s16, s84
    s_mov_b32 s17, s85
    s_mov_b32 s18, 4718592
    s_mov_b32 s19, 0x20000
    s_and_b32 s33, s2, 31
    s_lshl_b32 s34, s33, 8
    s_lshl_b32 s35, s3, 19
    s_add_u32 s34, s34, s35
    s_lshl_b32 s35, s3, 14
    v_lshlrev_b32 v5, 1, v1
    v_xor_b32 v5, v5, v2
    v_lshlrev_b32 v5, 4, v5
    v_lshl_add_u32 v5, v1, 13, v5
    v_xor_b32 v6, 0x80, v5
    s_lshr_b32 s40, s3, 1
    s_lshl_b32 s36, s40, 4
    s_add_u32 s36, s36, 64
    v_add_u32 v13, s36, v2
    v_mov_b32 v14, v13
    v_lshlrev_b32 v14, 7, v14
    v_add_u32 v14, 32768, v14
    s_mov_b32 m0, s35
    s_waitcnt vmcnt(7)
    buffer_load_dwordx4 v5, s[12:15], s34 offen offset:0 nt lds
    s_add_u32 s34, s34, 32768
    s_add_u32 s35, s35, 1024
    s_mov_b32 m0, s35
    s_waitcnt vmcnt(7)
    buffer_load_dwordx4 v6, s[12:15], s34 offen offset:0 nt lds
    s_add_u32 s34, s34, 32768
    s_add_u32 s35, s35, 1024
    s_mov_b32 m0, s35
    s_waitcnt vmcnt(7)
    buffer_load_dwordx4 v5, s[12:15], s34 offen offset:0 nt lds
    s_add_u32 s34, s34, 32768
    s_add_u32 s35, s35, 1024
    s_mov_b32 m0, s35
    s_waitcnt vmcnt(7)
    buffer_load_dwordx4 v6, s[12:15], s34 offen offset:0 nt lds
    s_add_u32 s34, s34, 32768
    s_add_u32 s35, s35, 1024
    s_mov_b32 m0, s35
    s_waitcnt vmcnt(7)
    buffer_load_dwordx4 v5, s[12:15], s34 offen offset:0 nt lds
    s_add_u32 s34, s34, 32768
    s_add_u32 s35, s35, 1024
    s_mov_b32 m0, s35
    s_waitcnt vmcnt(7)
    buffer_load_dwordx4 v6, s[12:15], s34 offen offset:0 nt lds
    s_add_u32 s34, s34, 32768
    s_add_u32 s35, s35, 1024
    s_mov_b32 m0, s35
    s_waitcnt vmcnt(7)
    buffer_load_dwordx4 v5, s[12:15], s34 offen offset:0 nt lds
    s_add_u32 s34, s34, 32768
    s_add_u32 s35, s35, 1024
    s_mov_b32 m0, s35
    s_waitcnt vmcnt(7)
    buffer_load_dwordx4 v6, s[12:15], s34 offen offset:0 nt lds
    s_add_u32 s34, s34, 32768
    s_add_u32 s35, s35, 1024
    s_mov_b32 m0, s35
    s_waitcnt vmcnt(7)
    buffer_load_dwordx4 v5, s[12:15], s34 offen offset:0 nt lds
    s_add_u32 s34, s34, 32768
    s_add_u32 s35, s35, 1024
    s_mov_b32 m0, s35
    s_waitcnt vmcnt(7)
    buffer_load_dwordx4 v6, s[12:15], s34 offen offset:0 nt lds
    s_add_u32 s34, s34, 32768
    s_add_u32 s35, s35, 1024
    s_mov_b32 m0, s35
    s_waitcnt vmcnt(7)
    buffer_load_dwordx4 v5, s[12:15], s34 offen offset:0 nt lds
    s_add_u32 s34, s34, 32768
    s_add_u32 s35, s35, 1024
    s_mov_b32 m0, s35
    s_waitcnt vmcnt(7)
    buffer_load_dwordx4 v6, s[12:15], s34 offen offset:0 nt lds
    s_add_u32 s34, s34, 32768
    s_add_u32 s35, s35, 1024
    s_mov_b32 m0, s35
    s_waitcnt vmcnt(7)
    buffer_load_dwordx4 v5, s[12:15], s34 offen offset:0 nt lds
    s_add_u32 s34, s34, 32768
    s_add_u32 s35, s35, 1024
    s_mov_b32 m0, s35
    s_waitcnt vmcnt(7)
    buffer_load_dwordx4 v6, s[12:15], s34 offen offset:0 nt lds
    s_add_u32 s34, s34, 32768
    s_add_u32 s35, s35, 1024
    s_mov_b32 m0, s35
    s_waitcnt vmcnt(7)
    buffer_load_dwordx4 v5, s[12:15], s34 offen offset:0 nt lds
    s_add_u32 s34, s34, 32768
    s_add_u32 s35, s35, 1024
    s_mov_b32 m0, s35
    s_waitcnt vmcnt(7)
    buffer_load_dwordx4 v6, s[12:15], s34 offen offset:0 nt lds
    v_lshrrev_b32 v10, 2, v0
    v_and_b32 v11, 7, v10
    v_xor_b32 v11, s3, v11
    v_lshlrev_b32 v11, 5, v11
    v_lshl_add_u32 v11, v10, 8, v11
    v_and_b32 v10, 3, v0
    v_lshl_add_u32 v8, v10, 3, v11
    v_add_u32 v9, 0x10000, v8
    s_waitcnt vmcnt(0)
    s_barrier
    ds_read_b64_tr_b16 v[192:193], v8 offset:0
    ds_read_b64_tr_b16 v[194:195], v8 offset:4096
    ds_read_b64_tr_b16 v[196:197], v8 offset:8192
    ds_read_b64_tr_b16 v[198:199], v8 offset:12288
    ds_read_b64_tr_b16 v[200:201], v8 offset:16384
    ds_read_b64_tr_b16 v[202:203], v8 offset:20480
    ds_read_b64_tr_b16 v[204:205], v8 offset:24576
    ds_read_b64_tr_b16 v[206:207], v8 offset:28672
    s_waitcnt lgkmcnt(7)
    ds_read_b64_tr_b16 v[208:209], v8 offset:32768
    ds_read_b64_tr_b16 v[210:211], v8 offset:36864
    ds_read_b64_tr_b16 v[212:213], v8 offset:40960
    ds_read_b64_tr_b16 v[214:215], v8 offset:45056
    ds_read_b64_tr_b16 v[216:217], v8 offset:49152
    ds_read_b64_tr_b16 v[218:219], v8 offset:53248
    ds_read_b64_tr_b16 v[220:221], v8 offset:57344
    ds_read_b64_tr_b16 v[222:223], v8 offset:61440
    s_waitcnt lgkmcnt(7)
    ds_read_b64_tr_b16 v[224:225], v9 offset:0
    ds_read_b64_tr_b16 v[226:227], v9 offset:4096
    ds_read_b64_tr_b16 v[228:229], v9 offset:8192
    ds_read_b64_tr_b16 v[230:231], v9 offset:12288
    ds_read_b64_tr_b16 v[232:233], v9 offset:16384
    ds_read_b64_tr_b16 v[234:235], v9 offset:20480
    ds_read_b64_tr_b16 v[236:237], v9 offset:24576
    ds_read_b64_tr_b16 v[238:239], v9 offset:28672
    s_waitcnt lgkmcnt(7)
    ds_read_b64_tr_b16 v[240:241], v9 offset:32768
    ds_read_b64_tr_b16 v[242:243], v9 offset:36864
    ds_read_b64_tr_b16 v[244:245], v9 offset:40960
    ds_read_b64_tr_b16 v[246:247], v9 offset:45056
    ds_read_b64_tr_b16 v[248:249], v9 offset:49152
    ds_read_b64_tr_b16 v[250:251], v9 offset:53248
    ds_read_b64_tr_b16 v[252:253], v9 offset:57344
    ds_read_b64_tr_b16 v[254:255], v9 offset:61440
    s_waitcnt lgkmcnt(7)
    s_waitcnt lgkmcnt(0)
    s_barrier
    s_mul_i32 s36, s33, 147456
    s_mul_i32 s37, s3, 1024
    s_add_u32 s36, s36, s37
    s_add_u32 s34, s36, 0
    s_add_u32 m0, s37, 0
    s_waitcnt vmcnt(7)
    buffer_load_dwordx4 v4, s[16:19], s34 offen offset:0 nt lds
    s_add_u32 s34, s36, 32768
    s_add_u32 m0, s37, 32768
    s_waitcnt vmcnt(7)
    buffer_load_dwordx4 v4, s[16:19], s34 offen offset:0 nt lds
    s_add_u32 s34, s36, 65536
    s_add_u32 m0, s37, 65536
    s_waitcnt vmcnt(7)
    buffer_load_dwordx4 v4, s[16:19], s34 offen offset:0 nt lds
    s_add_u32 s34, s36, 98304
    s_add_u32 m0, s37, 98304
    s_waitcnt vmcnt(7)
    buffer_load_dwordx4 v4, s[16:19], s34 offen offset:0 nt lds
    s_add_u32 s34, s36, 131072
    s_add_u32 m0, s37, 131072
    s_waitcnt vmcnt(7)
    buffer_load_dwordx4 v4, s[16:19], s34 offen offset:0 nt lds
    s_add_u32 s34, s36, 8192
    s_add_u32 m0, s37, 8192
    s_waitcnt vmcnt(7)
    buffer_load_dwordx4 v4, s[16:19], s34 offen offset:0 nt lds
    s_add_u32 s34, s36, 40960
    s_add_u32 m0, s37, 40960
    s_waitcnt vmcnt(7)
    buffer_load_dwordx4 v4, s[16:19], s34 offen offset:0 nt lds
    s_add_u32 s34, s36, 73728
    s_add_u32 m0, s37, 73728
    s_waitcnt vmcnt(7)
    buffer_load_dwordx4 v4, s[16:19], s34 offen offset:0 nt lds
    s_add_u32 s34, s36, 106496
    s_add_u32 m0, s37, 106496
    s_waitcnt vmcnt(7)
    buffer_load_dwordx4 v4, s[16:19], s34 offen offset:0 nt lds
    s_add_u32 s34, s36, 139264
    s_add_u32 m0, s37, 139264
    s_waitcnt vmcnt(7)
    buffer_load_dwordx4 v4, s[16:19], s34 offen offset:0 nt lds
    s_add_u32 s34, s36, 16384
    s_add_u32 m0, s37, 16384
    s_waitcnt vmcnt(7)
    buffer_load_dwordx4 v4, s[16:19], s34 offen offset:0 nt lds
    s_add_u32 s34, s36, 49152
    s_add_u32 m0, s37, 49152
    s_waitcnt vmcnt(7)
    buffer_load_dwordx4 v4, s[16:19], s34 offen offset:0 nt lds
    s_add_u32 s34, s36, 81920
    s_add_u32 m0, s37, 81920
    s_waitcnt vmcnt(7)
    buffer_load_dwordx4 v4, s[16:19], s34 offen offset:0 nt lds
    s_add_u32 s34, s36, 114688
    s_add_u32 m0, s37, 114688
    s_waitcnt vmcnt(7)
    buffer_load_dwordx4 v4, s[16:19], s34 offen offset:0 nt lds
    s_add_u32 s34, s36, 24576
    s_add_u32 m0, s37, 24576
    s_waitcnt vmcnt(7)
    buffer_load_dwordx4 v4, s[16:19], s34 offen offset:0 nt lds
    s_add_u32 s34, s36, 57344
    s_add_u32 m0, s37, 57344
    s_waitcnt vmcnt(7)
    buffer_load_dwordx4 v4, s[16:19], s34 offen offset:0 nt lds
    s_add_u32 s34, s36, 90112
    s_add_u32 m0, s37, 90112
    s_waitcnt vmcnt(7)
    buffer_load_dwordx4 v4, s[16:19], s34 offen offset:0 nt lds
    s_add_u32 s34, s36, 122880
    s_add_u32 m0, s37, 122880
    s_waitcnt vmcnt(7)
    buffer_load_dwordx4 v4, s[16:19], s34 offen offset:0 nt lds
    v_lshlrev_b32 v5, 3, v1
    v_bfe_u32 v8, v0, 2, 2
    v_add_u32 v5, v5, v8
    v_mul_u32_u24 v5, 1152, v5
    v_and_b32 v8, 3, v0
    v_lshl_add_u32 v5, v8, 3, v5
    s_and_b32 s39, s3, 3
    s_lshl_b32 s39, s39, 5
    s_add_u32 s39, s39, 1024
    v_add_u32 v10, s39, v5
    s_lshl_b32 s39, s3, 7
    v_add_u32 v5, s39, v5
    v_add_u32 v9, 73728, v5
    v_add_u32 v11, 73728, v10
    s_waitcnt vmcnt(0)
    s_barrier
    ds_read_b64_tr_b16 v[112:113], v5 offset:0
    ds_read_b64_tr_b16 v[114:115], v5 offset:4608
    ds_read_b64_tr_b16 v[116:117], v5 offset:36864
    ds_read_b64_tr_b16 v[118:119], v5 offset:41472
    ds_read_b64_tr_b16 v[120:121], v9 offset:0
    ds_read_b64_tr_b16 v[122:123], v9 offset:4608
    ds_read_b64_tr_b16 v[124:125], v9 offset:36864
    ds_read_b64_tr_b16 v[126:127], v9 offset:41472
    s_waitcnt lgkmcnt(7)
    ds_read_b64_tr_b16 v[128:129], v5 offset:32
    ds_read_b64_tr_b16 v[130:131], v5 offset:4640
    ds_read_b64_tr_b16 v[132:133], v5 offset:36896
    ds_read_b64_tr_b16 v[134:135], v5 offset:41504
    ds_read_b64_tr_b16 v[136:137], v9 offset:32
    ds_read_b64_tr_b16 v[138:139], v9 offset:4640
    ds_read_b64_tr_b16 v[140:141], v9 offset:36896
    ds_read_b64_tr_b16 v[142:143], v9 offset:41504
    s_waitcnt lgkmcnt(7)
    ds_read_b64_tr_b16 v[144:145], v5 offset:64
    ds_read_b64_tr_b16 v[146:147], v5 offset:4672
    ds_read_b64_tr_b16 v[148:149], v5 offset:36928
    ds_read_b64_tr_b16 v[150:151], v5 offset:41536
    ds_read_b64_tr_b16 v[152:153], v9 offset:64
    ds_read_b64_tr_b16 v[154:155], v9 offset:4672
    ds_read_b64_tr_b16 v[156:157], v9 offset:36928
    ds_read_b64_tr_b16 v[158:159], v9 offset:41536
    s_waitcnt lgkmcnt(7)
    ds_read_b64_tr_b16 v[160:161], v5 offset:96
    ds_read_b64_tr_b16 v[162:163], v5 offset:4704
    ds_read_b64_tr_b16 v[164:165], v5 offset:36960
    ds_read_b64_tr_b16 v[166:167], v5 offset:41568
    ds_read_b64_tr_b16 v[168:169], v9 offset:96
    ds_read_b64_tr_b16 v[170:171], v9 offset:4704
    ds_read_b64_tr_b16 v[172:173], v9 offset:36960
    ds_read_b64_tr_b16 v[174:175], v9 offset:41568
    s_waitcnt lgkmcnt(7)
    ds_read_b64_tr_b16 v[176:177], v10 offset:0
    ds_read_b64_tr_b16 v[178:179], v10 offset:4608
    ds_read_b64_tr_b16 v[180:181], v10 offset:36864
    ds_read_b64_tr_b16 v[182:183], v10 offset:41472
    ds_read_b64_tr_b16 v[184:185], v11 offset:0
    ds_read_b64_tr_b16 v[186:187], v11 offset:4608
    ds_read_b64_tr_b16 v[188:189], v11 offset:36864
    ds_read_b64_tr_b16 v[190:191], v11 offset:41472
    s_waitcnt lgkmcnt(7)
    v_lshlrev_b32 v5, 10, v13
    s_lshl_b32 s36, s33, 3
    s_add_u32 s36, s36, 328192
    s_lshl_b32 s37, s3, 18
    s_lshl_b32 s39, s33, 10
    s_add_u32 s37, s37, s39
    s_add_u32 s37, s37, 2097152
    s_mul_i32 s39, s3, 1088
    s_add_u32 s39, s39, 151680
    v_add_u32 v8, s39, v4
    v_and_b32 v9, 3, v2
    v_lshlrev_b32 v9, 1, v9
    v_bfe_u32 v10, v0, 2, 1
    v_add_u32 v9, v9, v10
    v_mul_u32_u24 v9, 1088, v9
    v_lshl_add_u32 v9, v1, 4, v9
    v_add_u32 v9, 151680, v9
    v_and_b32 v10, 3, v2
    v_mul_u32_u24 v10, 272, v10
    v_lshl_add_u32 v10, v1, 3, v10
    s_lshl_b32 s39, s3, 5
    s_add_u32 s39, s39, 160384
    v_add_u32 v10, s39, v10
    v_lshrrev_b32 v11, 2, v2
    v_mul_u32_u24 v11, 272, v11
    v_lshl_add_u32 v11, v1, 4, v11
    v_add_u32 v11, 160384, v11
    s_mul_i32 s38, s33, 9216
    s_add_u32 s38, s38, 884736
    s_lshl_b32 s39, s3, 8
    s_add_u32 s39, s39, s38
    s_add_u32 s39, s39, 8192
    s_lshl_b32 s42, s3, 10
    s_add_u32 s38, s38, s42
    v_lshlrev_b32 v12, 2, v0
    s_and_b32 s42, s3, 1
    s_lshl_b32 s42, s42, 3
    v_mov_b32 v16, 151664
    s_mov_b32 s29, 1600000
L_wl_43:
    ds_read_b32 v17, v16
    s_sub_u32 s29, s29, 1
    s_cbranch_scc1 L_wl_43_x
    s_waitcnt lgkmcnt(0)
    v_readfirstlane_b32 s28, v17
    s_cmp_ge_u32 s28, 1
    s_nop 2
    s_cbranch_scc1 L_wl_43_x
    s_sleep 1
    s_branch L_wl_43
L_wl_43_x:
    s_waitcnt lgkmcnt(0)
    ds_read_b32 v17, v16 offset:4
    s_waitcnt lgkmcnt(0)
    v_readfirstlane_b32 s63, v17
    s_mov_b32 s29, 200000
L_cf_44:
    buffer_load_dword v17, v14, s[4:7], 0 offen sc1
    s_sub_u32 s29, s29, 1
    s_nop 0
    s_cbranch_scc1 L_cf_44_x
    s_waitcnt vmcnt(0)
    v_cmp_ne_u32 vcc, s63, v17
    s_nop 3
    s_cbranch_vccz L_cf_44_x
    s_mov_b64 exec, vcc
    s_sleep 4
    s_branch L_cf_44
L_cf_44_x:
    s_mov_b64 exec, -1
    s_waitcnt vmcnt(0)
    s_mov_b64 exec, 0xffff
    s_mov_b32 s29, 200000
L_poll_45:
    buffer_load_dwordx2 v[18:19], v5, s[4:7], s36 offen sc1
    s_sub_u32 s29, s29, 1
    s_cbranch_scc1 L_poll_45_x
    s_waitcnt vmcnt(0)
    v_max_u32 v16, v18, v19
    v_cmp_eq_u32 vcc, -1, v16
    s_nop 3
    s_cbranch_vccz L_poll_45_x
    s_mov_b64 exec, vcc
    s_sleep 2
    s_branch L_poll_45
L_poll_45_x:
    s_mov_b64 exec, -1
    s_waitcnt vmcnt(0)
    buffer_load_dwordx4 v[48:51], v4, s[4:7], s37 offen sc1
    s_add_u32 s37, s37, 32768
    buffer_load_dwordx4 v[52:55], v4, s[4:7], s37 offen sc1
    s_add_u32 s37, s37, 32768
    buffer_load_dwordx4 v[56:59], v4, s[4:7], s37 offen sc1
    s_add_u32 s37, s37, 32768
    buffer_load_dwordx4 v[60:63], v4, s[4:7], s37 offen sc1
    s_add_u32 s37, s37, 32768
    buffer_load_dwordx4 v[64:67], v4, s[4:7], s37 offen sc1
    s_add_u32 s37, s37, 32768
    buffer_load_dwordx4 v[68:71], v4, s[4:7], s37 offen sc1
    s_add_u32 s37, s37, 32768
    buffer_load_dwordx4 v[72:75], v4, s[4:7], s37 offen sc1
    s_add_u32 s37, s37, 32768
    buffer_load_dwordx4 v[76:79], v4, s[4:7], s37 offen sc1
    s_add_u32 s37, s37, 32768
    v_mov_b32 v20, v18
    s_nop 1
    v_max_f32_dpp v20, v20, v20 quad_perm:[1,0,3,2] row_mask:0xf bank_mask:0xf
    s_nop 1
    v_max_f32_dpp v20, v20, v20 quad_perm:[2,3,0,1] row_mask:0xf bank_mask:0xf
    s_nop 1
    v_max_f32_dpp v20, v20, v20 row_ror:4 row_mask:0xf bank_mask:0xf
    s_nop 1
    v_max_f32_dpp v20, v20, v20 row_ror:8 row_mask:0xf bank_mask:0xf
    v_sub_f32 v21, v18, v20
    v_exp_f32 v21, v21
    s_nop 0
    v_mul_f32 v22, v21, v19
    s_nop 1
    v_add_f32_dpp v22, v22, v22 quad_perm:[1,0,3,2] row_mask:0xf bank_mask:0xf
    s_nop 1
    v_add_f32_dpp v22, v22, v22 quad_perm:[2,3,0,1] row_mask:0xf bank_mask:0xf
    s_nop 1
    v_add_f32_dpp v22, v22, v22 row_ror:4 row_mask:0xf bank_mask:0xf
    s_nop 1
    v_add_f32_dpp v22, v22, v22 row_ror:8 row_mask:0xf bank_mask:0xf
    v_rcp_f32 v22, v22
    s_nop 0
    v_mul_f32 v21, v21, v22
    s_nop 0
    v_readlane_b32 s41, v21, s42
    s_add_u32 s42, s42, 1
    s_waitcnt vmcnt(7)
    v_lshlrev_b32 v32, 16, v48
    v_and_b32 v33, 0xffff0000, v48
    v_lshlrev_b32 v34, 16, v49
    v_and_b32 v35, 0xffff0000, v49
    v_lshlrev_b32 v36, 16, v50
    v_and_b32 v37, 0xffff0000, v50
    v_lshlrev_b32 v38, 16, v51
    v_and_b32 v39, 0xffff0000, v51
    v_mul_f32 v24, s41, v32
    v_mul_f32 v25, s41, v33
    v_mul_f32 v26, s41, v34
    v_mul_f32 v27, s41, v35
    v_mul_f32 v28, s41, v36
    v_mul_f32 v29, s41, v37
    v_mul_f32 v30, s41, v38
    v_mul_f32 v31, s41, v39
    v_readlane_b32 s41, v21, s42
    s_add_u32 s42, s42, 1
    s_waitcnt vmcnt(6)
    v_lshlrev_b32 v32, 16, v52
    v_and_b32 v33, 0xffff0000, v52
    v_lshlrev_b32 v34, 16, v53
    v_and_b32 v35, 0xffff0000, v53
    v_lshlrev_b32 v36, 16, v54
    v_and_b32 v37, 0xffff0000, v54
    v_lshlrev_b32 v38, 16, v55
    v_and_b32 v39, 0xffff0000, v55
    v_fmac_f32 v24, s41, v32
    v_fmac_f32 v25, s41, v33
    v_fmac_f32 v26, s41, v34
    v_fmac_f32 v27, s41, v35
    v_fmac_f32 v28, s41, v36
    v_fmac_f32 v29, s41, v37
    v_fmac_f32 v30, s41, v38
    v_fmac_f32 v31, s41, v39
    v_readlane_b32 s41, v21, s42
    s_add_u32 s42, s42, 1
    s_waitcnt vmcnt(5)
    v_lshlrev_b32 v32, 16, v56
    v_and_b32 v33, 0xffff0000, v56
    v_lshlrev_b32 v34, 16, v57
    v_and_b32 v35, 0xffff0000, v57
    v_lshlrev_b32 v36, 16, v58
    v_and_b32 v37, 0xffff0000, v58
    v_lshlrev_b32 v38, 16, v59
    v_and_b32 v39, 0xffff0000, v59
    v_fmac_f32 v24, s41, v32
    v_fmac_f32 v25, s41, v33
    v_fmac_f32 v26, s41, v34
    v_fmac_f32 v27, s41, v35
    v_fmac_f32 v28, s41, v36
    v_fmac_f32 v29, s41, v37
    v_fmac_f32 v30, s41, v38
    v_fmac_f32 v31, s41, v39
    v_readlane_b32 s41, v21, s42
    s_add_u32 s42, s42, 1
    s_waitcnt vmcnt(4)
    v_lshlrev_b32 v32, 16, v60
    v_and_b32 v33, 0xffff0000, v60
    v_lshlrev_b32 v34, 16, v61
    v_and_b32 v35, 0xffff0000, v61
    v_lshlrev_b32 v36, 16, v62
    v_and_b32 v37, 0xffff0000, v62
    v_lshlrev_b32 v38, 16, v63
    v_and_b32 v39, 0xffff0000, v63
    v_fmac_f32 v24, s41, v32
    v_fmac_f32 v25, s41, v33
    v_fmac_f32 v26, s41, v34
    v_fmac_f32 v27, s41, v35
    v_fmac_f32 v28, s41, v36
    v_fmac_f32 v29, s41, v37
    v_fmac_f32 v30, s41, v38
    v_fmac_f32 v31, s41, v39
    v_readlane_b32 s41, v21, s42
    s_add_u32 s42, s42, 1
    s_waitcnt vmcnt(3)
    v_lshlrev_b32 v32, 16, v64
    v_and_b32 v33, 0xffff0000, v64
    v_lshlrev_b32 v34, 16, v65
    v_and_b32 v35, 0xffff0000, v65
    v_lshlrev_b32 v36, 16, v66
    v_and_b32 v37, 0xffff0000, v66
    v_lshlrev_b32 v38, 16, v67
    v_and_b32 v39, 0xffff0000, v67
    v_fmac_f32 v24, s41, v32
    v_fmac_f32 v25, s41, v33
    v_fmac_f32 v26, s41, v34
    v_fmac_f32 v27, s41, v35
    v_fmac_f32 v28, s41, v36
    v_fmac_f32 v29, s41, v37
    v_fmac_f32 v30, s41, v38
    v_fmac_f32 v31, s41, v39
    v_readlane_b32 s41, v21, s42
    s_add_u32 s42, s42, 1
    s_waitcnt vmcnt(2)
    v_lshlrev_b32 v32, 16, v68
    v_and_b32 v33, 0xffff0000, v68
    v_lshlrev_b32 v34, 16, v69
    v_and_b32 v35, 0xffff0000, v69
    v_lshlrev_b32 v36, 16, v70
    v_and_b32 v37, 0xffff0000, v70
    v_lshlrev_b32 v38, 16, v71
    v_and_b32 v39, 0xffff0000, v71
    v_fmac_f32 v24, s41, v32
    v_fmac_f32 v25, s41, v33
    v_fmac_f32 v26, s41, v34
    v_fmac_f32 v27, s41, v35
    v_fmac_f32 v28, s41, v36
    v_fmac_f32 v29, s41, v37
    v_fmac_f32 v30, s41, v38
    v_fmac_f32 v31, s41, v39
    v_readlane_b32 s41, v21, s42
    s_add_u32 s42, s42, 1
    s_waitcnt vmcnt(1)
    v_lshlrev_b32 v32, 16, v72
    v_and_b32 v33, 0xffff0000, v72
    v_lshlrev_b32 v34, 16, v73
    v_and_b32 v35, 0xffff0000, v73
    v_lshlrev_b32 v36, 16, v74
    v_and_b32 v37, 0xffff0000, v74
    v_lshlrev_b32 v38, 16, v75
    v_and_b32 v39, 0xffff0000, v75
    v_fmac_f32 v24, s41, v32
    v_fmac_f32 v25, s41, v33
    v_fmac_f32 v26, s41, v34
    v_fmac_f32 v27, s41, v35
    v_fmac_f32 v28, s41, v36
    v_fmac_f32 v29, s41, v37
    v_fmac_f32 v30, s41, v38
    v_fmac_f32 v31, s41, v39
    v_readlane_b32 s41, v21, s42
    s_add_u32 s42, s42, 1
    s_waitcnt vmcnt(0)
    v_lshlrev_b32 v32, 16, v76
    v_and_b32 v33, 0xffff0000, v76
    v_lshlrev_b32 v34, 16, v77
    v_and_b32 v35, 0xffff0000, v77
    v_lshlrev_b32 v36, 16, v78
    v_and_b32 v37, 0xffff0000, v78
    v_lshlrev_b32 v38, 16, v79
    v_and_b32 v39, 0xffff0000, v79
    v_fmac_f32 v24, s41, v32
    v_fmac_f32 v25, s41, v33
    v_fmac_f32 v26, s41, v34
    v_fmac_f32 v27, s41, v35
    v_fmac_f32 v28, s41, v36
    v_fmac_f32 v29, s41, v37
    v_fmac_f32 v30, s41, v38
    v_fmac_f32 v31, s41, v39
    v_cvt_pk_bf16_f32 v32, v24, v25
    v_cvt_pk_bf16_f32 v33, v26, v27
    v_cvt_pk_bf16_f32 v34, v28, v29
    v_cvt_pk_bf16_f32 v35, v30, v31
    ds_write_b128 v8, v[32:35]
    s_waitcnt lgkmcnt(0)
    s_barrier
    ds_read_b128 v[48:51], v9 offset:0
    ds_read_b128 v[52:55], v9 offset:64
    ds_read_b128 v[56:59], v9 offset:128
    ds_read_b128 v[60:63], v9 offset:192
    ds_read_b128 v[64:67], v9 offset:256
    ds_read_b128 v[68:71], v9 offset:320
    ds_read_b128 v[72:75], v9 offset:384
    ds_read_b128 v[76:79], v9 offset:448
    ds_read_b128 v[80:83], v9 offset:512
    ds_read_b128 v[84:87], v9 offset:576
    ds_read_b128 v[88:91], v9 offset:640
    ds_read_b128 v[92:95], v9 offset:704
    ds_read_b128 v[96:99], v9 offset:768
    s_waitcnt lgkmcnt(12)
    v_mfma_f32_16x16x32_bf16 v[24:27], v[192:195], v[48:51], 0
    ds_read_b128 v[100:103], v9 offset:832
    s_waitcnt lgkmcnt(12)
    v_mfma_f32_16x16x32_bf16 v[28:31], v[196:199], v[52:55], 0
    ds_read_b128 v[104:107], v9 offset:896
    s_waitcnt lgkmcnt(12)
    v_mfma_f32_16x16x32_bf16 v[24:27], v[200:203], v[56:59], v[24:27]
    ds_read_b128 v[108:111], v9 offset:960
    s_waitcnt lgkmcnt(12)
    v_mfma_f32_16x16x32_bf16 v[28:31], v[204:207], v[60:63], v[28:31]
    s_waitcnt lgkmcnt(11)
    v_mfma_f32_16x16x32_bf16 v[24:27], v[208:211], v[64:67], v[24:27]
    s_waitcnt lgkmcnt(10)
    v_mfma_f32_16x16x32_bf16 v[28:31], v[212:215], v[68:71], v[28:31]
    s_waitcnt lgkmcnt(9)
    v_mfma_f32_16x16x32_bf16 v[24:27], v[216:219], v[72:75], v[24:27]
    s_waitcnt lgkmcnt(8)
    v_mfma_f32_16x16x32_bf16 v[28:31], v[220:223], v[76:79], v[28:31]
    s_waitcnt lgkmcnt(7)
    v_mfma_f32_16x16x32_bf16 v[24:27], v[224:227], v[80:83], v[24:27]
    s_waitcnt lgkmcnt(6)
    v_mfma_f32_16x16x32_bf16 v[28:31], v[228:231], v[84:87], v[28:31]
    s_waitcnt lgkmcnt(5)
    v_mfma_f32_16x16x32_bf16 v[24:27], v[232:235], v[88:91], v[24:27]
    s_waitcnt lgkmcnt(4)
    v_mfma_f32_16x16x32_bf16 v[28:31], v[236:239], v[92:95], v[28:31]
    s_waitcnt lgkmcnt(3)
    v_mfma_f32_16x16x32_bf16 v[24:27], v[240:243], v[96:99], v[24:27]
    s_waitcnt lgkmcnt(2)
    v_mfma_f32_16x16x32_bf16 v[28:31], v[244:247], v[100:103], v[28:31]
    s_waitcnt lgkmcnt(1)
    v_mfma_f32_16x16x32_bf16 v[24:27], v[248:251], v[104:107], v[24:27]
    s_waitcnt lgkmcnt(0)
    v_mfma_f32_16x16x32_bf16 v[28:31], v[252:255], v[108:111], v[28:31]
    s_nop 7
    v_add_f32 v24, v24, v28
    v_add_f32 v25, v25, v29
    v_add_f32 v26, v26, v30
    v_add_f32 v27, v27, v31
    v_add_f32_dpp v24, v24, v24 row_ror:4 row_mask:0xf bank_mask:0xf
    v_add_f32_dpp v25, v25, v25 row_ror:4 row_mask:0xf bank_mask:0xf
    v_add_f32_dpp v26, v26, v26 row_ror:4 row_mask:0xf bank_mask:0xf
    v_add_f32_dpp v27, v27, v27 row_ror:4 row_mask:0xf bank_mask:0xf
    v_cvt_pk_bf16_f32 v32, v24, v25
    v_cvt_pk_bf16_f32 v33, v26, v27
    ds_write_b64 v10, v[32:33]
    s_waitcnt lgkmcnt(0)
    s_barrier
    ds_read_b128 v[24:27], v11 offset:0
    ds_read_b128 v[28:31], v11 offset:64
    ds_read_b128 v[32:35], v11 offset:128
    ds_read_b128 v[36:39], v11 offset:192
    s_waitcnt lgkmcnt(3)
    v_mfma_f32_16x16x32_bf16 v[64:67], v[24:27], v[112:115], 0
    v_mfma_f32_16x16x32_bf16 v[68:71], v[24:27], v[128:131], 0
    v_mfma_f32_16x16x32_bf16 v[72:75], v[24:27], v[144:147], 0
    v_mfma_f32_16x16x32_bf16 v[76:79], v[24:27], v[160:163], 0
    v_mfma_f32_16x16x32_bf16 v[80:83], v[24:27], v[176:179], 0
    s_waitcnt lgkmcnt(2)
    v_mfma_f32_16x16x32_bf16 v[64:67], v[28:31], v[116:119], v[64:67]
    v_mfma_f32_16x16x32_bf16 v[68:71], v[28:31], v[132:135], v[68:71]
    v_mfma_f32_16x16x32_bf16 v[72:75], v[28:31], v[148:151], v[72:75]
    v_mfma_f32_16x16x32_bf16 v[76:79], v[28:31], v[164:167], v[76:79]
    v_mfma_f32_16x16x32_bf16 v[80:83], v[28:31], v[180:183], v[80:83]
    s_waitcnt lgkmcnt(1)
    v_mfma_f32_16x16x32_bf16 v[64:67], v[32:35], v[120:123], v[64:67]
    v_mfma_f32_16x16x32_bf16 v[68:71], v[32:35], v[136:139], v[68:71]
    v_mfma_f32_16x16x32_bf16 v[72:75], v[32:35], v[152:155], v[72:75]
    v_mfma_f32_16x16x32_bf16 v[76:79], v[32:35], v[168:171], v[76:79]
    v_mfma_f32_16x16x32_bf16 v[80:83], v[32:35], v[184:187], v[80:83]
    s_waitcnt lgkmcnt(0)
    v_mfma_f32_16x16x32_bf16 v[64:67], v[36:39], v[124:127], v[64:67]
    v_mfma_f32_16x16x32_bf16 v[68:71], v[36:39], v[140:143], v[68:71]
    v_mfma_f32_16x16x32_bf16 v[72:75], v[36:39], v[156:159], v[72:75]
    v_mfma_f32_16x16x32_bf16 v[76:79], v[36:39], v[172:175], v[76:79]
    v_mfma_f32_16x16x32_bf16 v[80:83], v[36:39], v[188:191], v[80:83]
    s_nop 3
    v_min_u32 v48, -2, v64
    v_min_u32 v49, -2, v68
    v_min_u32 v50, -2, v72
    v_min_u32 v51, -2, v76
    v_min_u32 v52, -2, v80
    buffer_store_dwordx4 v[48:51], v4, s[4:7], s38 offen sc1
    s_cmp_ge_u32 s3, 4
    s_cbranch_scc1 L_bh2s_46
    buffer_store_dword v52, v12, s[4:7], s39 offen sc1
L_bh2s_46:
    s_branch L_fin
L_awave:
    s_sub_u32 s44, s3, 4
    s_cmp_lg_u32 s3, 4
    s_cbranch_scc1 L_clrf_47
    s_waitcnt lgkmcnt(0)
    s_mul_i32 s63, s63, 0x9E3779B1
    s_add_u32 s63, s63, 0x7F4A7C15
    v_mov_b32 v8, s63
    v_mov_b32 v9, s63
    v_mov_b32 v10, s63
    v_mov_b32 v11, s63
    v_mov_b32 v12, 1
    v_mov_b32 v13, s63
    v_mov_b32 v14, 151664
    s_lshl_b32 s31, s2, 7
    s_add_u32 s31, s31, 32768
    s_waitcnt vmcnt(0)
    s_mov_b64 exec, 0xff
    buffer_store_dwordx4 v[8:11], v4, s[4:7], s30 offen offset:896 sc1
    buffer_store_dwordx4 v[8:11], v4, s[4:7], s31 offen sc1
    s_mov_b64 exec, 1
    ds_write_b64 v14, v[12:13]
    s_mov_b64 exec, -1
    s_setprio 0
L_clrf_47:
    s_lshr_b32 s28, s2, 5
    s_cmp_eq_u32 s28, 6
    s_cbranch_scc1 L_bh2
    s_lshr_b32 s28, s2, 6
    s_cmp_eq_u32 s28, 1
    s_cbranch_scc1 L_ba_a
L_amain:
    s_mov_b32 s12, s66
    s_mov_b32 s13, s67
    s_mov_b32 s14, 67108864
    s_mov_b32 s15, 0x20000
    s_mov_b32 s16, s68
    s_mov_b32 s17, s69
    s_mov_b32 s18, 67108864
    s_mov_b32 s19, 0x20000
    s_lshl_b32 s49, s45, 20
    s_mul_i32 s33, s45, 37
    s_cmp_lt_u32 s45, 32
    s_cselect_b32 s32, 12, 16
    s_lshl_b32 s30, s46, 2
    s_add_u32 s30, s30, s44
    s_add_u32 s30, s30, s33
    s_add_u32 s31, s30, s32
    s_and_b32 s30, s30, 127
    s_and_b32 s31, s31, 127
    s_mov_b32 s29, 0
    s_bfe_u32 s57, s30, 327680
    s_lshl_b32 s57, s57, 8
    s_or_b32 s29, s29, s57
    s_bfe_u32 s57, s30, 65541
    s_lshl_b32 s57, s57, 14
    s_or_b32 s29, s29, s57
    s_bfe_u32 s57, s30, 65542
    s_lshl_b32 s57, s57, 19
    s_or_b32 s29, s29, s57
    s_mov_b32 s30, s29
    s_mov_b32 s29, 0
    s_bfe_u32 s57, s31, 327680
    s_lshl_b32 s57, s57, 8
    s_or_b32 s29, s29, s57
    s_bfe_u32 s57, s31, 65541
    s_lshl_b32 s57, s57, 14
    s_or_b32 s29, s29, s57
    s_bfe_u32 s57, s31, 65542
    s_lshl_b32 s57, s57, 19
    s_or_b32 s29, s29, s57
    s_mov_b32 s31, s29
    s_add_u32 s30, s30, s49
    s_add_u32 s31, s31, s49
    s_lshl_b32 s28, s46, 2
    s_add_u32 s28, s28, s44
    s_sub_u32 s28, s28, s32
    s_sub_u32 s28, s28, 1
    v_mov_b32 v224, s28
    s_mul_i32 s32, s32, 3
    s_add_u32 s33, s33, s32
    s_sub_u32 s32, 128, s32
    s_lshl_b32 s35, s44, 3
    s_lshr_b32 s35, 0, s35
    s_and_b32 s35, s35, 0xff
    s_sub_u32 s35, s32, s35
    s_mov_b32 s34, 1
    s_lshl_b32 s48, s45, 12
    s_add_u32 s48, s48, 66304
    s_mov_b32 s50, 0x05040100
    s_mov_b32 s51, 0x07060302
    v_lshlrev_b32 v4, 4, v0
    v_mov_b32 v1, v4
    v_add_u32 v2, 4096, v4
    v_mov_b32 v3, 1040356334
    v_mov_b32 v4, 4286578687
    v_mov_b32 v5, 0
    v_and_b32 v6, 15, v0
    v_and_b32 v7, 1, v0
    v_lshlrev_b32 v6, 4, v6
    v_lshl_add_u32 v6, v7, 8, v6
    v_add_u32 v6, 158080, v6
    v_xor_b32 v7, 16, v6
    v_cmp_lt_u32 vcc, 31, v0
    v_mov_b32 v226, 0
    v_mov_b32 v227, 151656
    v_and_b32 v240, 15, v0
    v_lshlrev_b32 v240, 4, v240
    v_bfe_u32 v2, v0, 4, 1
    v_lshl_add_u32 v240, v2, 15, v240
    v_bfe_u32 v2, v0, 5, 1
    v_lshl_add_u32 v240, v2, 16, v240
    v_add_u32 v241, 8192, v240
    v_add_u32 v242, 131072, v240
    v_add_u32 v243, 139264, v240
    v_add_u32 v244, 262144, v240
    v_add_u32 v245, 270336, v240
    v_add_u32 v246, 393216, v240
    v_add_u32 v247, 401408, v240
    v_mov_b32 v32, 0
    v_mov_b32 v33, 0
    v_mov_b32 v34, 0
    v_mov_b32 v35, 0
    v_mov_b32 v36, 0
    v_mov_b32 v37, 0
    v_mov_b32 v38, 0
    v_mov_b32 v39, 0
    v_mov_b32 v40, 0
    v_mov_b32 v41, 0
    v_mov_b32 v42, 0
    v_mov_b32 v43, 0
    v_mov_b32 v44, 0
    v_mov_b32 v45, 0
    v_mov_b32 v46, 0
    v_mov_b32 v47, 0
    v_mov_b32 v48, 0
    v_mov_b32 v49, 0
    v_mov_b32 v50, 0
    v_mov_b32 v51, 0
    v_mov_b32 v52, 0
    v_mov_b32 v53, 0
    v_mov_b32 v54, 0
    v_mov_b32 v55, 0
    v_mov_b32 v56, 0
    v_mov_b32 v57, 0
    v_mov_b32 v58, 0
    v_mov_b32 v59, 0
    v_mov_b32 v60, 0
    v_mov_b32 v61, 0
    v_mov_b32 v62, 0
    v_mov_b32 v63, 0
    v_lshrrev_b32 v228, 4, v0
    v_and_b32 v229, 1, v0
    v_lshl_add_u32 v228, v228, 1, v229
    v_lshlrev_b32 v228, 4, v228
    s_lshl_b32 s53, s44, 10
    s_add_u32 s53, s53, 147456
    v_add_u32 v228, s53, v228
    s_lshl_b32 s53, s44, 4
    s_add_u32 s53, s53, 151552
    v_lshlrev_b32 v229, 3, v229
    v_add_u32 v230, s53, v229
    v_add_u32 v231, 151552, v229
    v_bfe_u32 v232, v0, 3, 2
    v_and_b32 v233, 7, v0
    v_lshlrev_b32 v233, 4, v233
    v_lshl_add_u32 v233, v232, 8, v233
    v_add_u32 v233, 147456, v233
    v_and_b32 v234, 1, v0
    v_lshlrev_b32 v234, 8, v234
    v_lshl_add_u32 v234, v232, 6, v234
    v_bfe_u32 v232, v0, 1, 2
    v_lshl_add_u32 v234, v232, 4, v234
    v_cndmask_b32 v234, v234, v1, vcc
    v_mov_b32 v236, 151676
    v_mov_b32 v237, 1
    s_lshl_b32 s54, s47, 10
    s_add_u32 s54, s54, 65536
    s_lshr_b32 s28, s2, 5
    s_cmp_lg_u32 s28, 4
    s_cbranch_scc1 L_t3q_48
    s_cmp_lg_u32 s3, 4
    s_cbranch_scc1 L_t3q_48
    s_and_b32 s52, s45, 15
    s_lshl_b32 s53, s52, 2
    s_add_u32 s53, s53, 64
    v_bfe_u32 v64, v0, 3, 2
    v_add_u32 v65, s53, v64
    v_lshlrev_b32 v65, 7, v65
    v_add_u32 v65, 32768, v65
    s_lshl_b32 s53, s45, 12
    s_add_u32 s53, s53, 66432
    v_mov_b32 v66, s53
    v_cmp_lt_u32 vcc, 31, v0
    s_nop 1
    v_cndmask_b32 v65, v65, v66, vcc
    v_and_b32 v66, 7, v0
    v_lshlrev_b32 v66, 4, v66
    v_lshl_add_u32 v66, v64, 10, v66
    s_lshl_b32 s52, s52, 12
    s_lshr_b32 s53, s45, 4
    s_lshl_b32 s53, s53, 7
    s_add_u32 s52, s52, s53
    s_add_u32 s52, s52, 393216
    v_lshlrev_b32 v67, 4, v0
    v_add_u32 v67, 158080, v67
    s_mov_b32 s29, 200000
L_cf_49:
    buffer_load_dword v73, v65, s[4:7], 0 offen sc1
    s_sub_u32 s29, s29, 1
    s_cbranch_scc1 L_cf_49_x
    s_waitcnt vmcnt(0)
    v_cmp_ne_u32 vcc, s63, v73
    s_nop 3
    s_cbranch_vccz L_cf_49_x
    s_mov_b64 exec, vcc
    s_sleep 4
    s_branch L_cf_49
L_cf_49_x:
    s_mov_b64 exec, -1
    s_waitcnt vmcnt(0)
    s_mov_b32 exec_hi, 0
    s_mov_b32 s29, 200000
L_poll_50:
    buffer_load_dwordx4 v[68:71], v66, s[4:7], s52 offen sc1
    s_sub_u32 s29, s29, 1
    s_cbranch_scc1 L_poll_50_x
    s_waitcnt vmcnt(0)
    v_max3_u32 v72, v68, v69, v70
    v_max_u32 v72, v72, v71
    v_cmp_eq_u32 vcc, -1, v72
    s_nop 3
    s_cbranch_vccz L_poll_50_x
    s_mov_b64 exec, vcc
    s_sleep 2
    s_branch L_poll_50
L_poll_50_x:
    s_mov_b64 exec, -1
    s_waitcnt vmcnt(0)
    s_mov_b32 exec_hi, 0
    ds_write_b128 v67, v[68:71]
    v_mov_b32 v72, 151652
    v_mov_b32 v73, 1
    ds_write_b32 v72, v73
    s_mov_b64 exec, -1
L_t3q_48:
    s_mov_b32 s29, 1600000
L_gw_51:
    ds_read_b32 v225, v227
    s_sub_u32 s29, s29, 1
    s_cbranch_scc1 L_gw_51_x
    s_waitcnt lgkmcnt(0)
    v_readfirstlane_b32 s28, v225
    s_cmp_gt_u32 s28, s44
    s_nop 2
    s_cbranch_scc1 L_gw_51_x
    s_sleep 1
    s_branch L_gw_51
L_gw_51_x:
    s_waitcnt lgkmcnt(0)
    s_waitcnt vmcnt(13)
    buffer_load_dwordx4 v[96:99], v240, s[12:15], s30 offen offset:0 nt
    s_waitcnt vmcnt(13)
    buffer_load_dwordx4 v[100:103], v242, s[12:15], s30 offen offset:0 nt
    s_waitcnt vmcnt(13)
    buffer_load_dwordx4 v[104:107], v244, s[12:15], s30 offen offset:0 nt
    s_waitcnt vmcnt(13)
    buffer_load_dwordx4 v[108:111], v246, s[12:15], s30 offen offset:0 nt
    s_waitcnt vmcnt(13)
    buffer_load_dwordx4 v[112:115], v241, s[12:15], s30 offen offset:0 nt
    s_waitcnt vmcnt(13)
    buffer_load_dwordx4 v[116:119], v243, s[12:15], s30 offen offset:0 nt
    s_waitcnt vmcnt(13)
    buffer_load_dwordx4 v[120:123], v245, s[12:15], s30 offen offset:0 nt
    s_waitcnt vmcnt(13)
    buffer_load_dwordx4 v[124:127], v247, s[12:15], s30 offen offset:0 nt
    s_waitcnt vmcnt(13)
    buffer_load_dwordx4 v[128:131], v240, s[16:19], s30 offen offset:0 nt
    s_waitcnt vmcnt(13)
    buffer_load_dwordx4 v[132:135], v242, s[16:19], s30 offen offset:0 nt
    s_waitcnt vmcnt(13)
    buffer_load_dwordx4 v[136:139], v244, s[16:19], s30 offen offset:0 nt
    s_waitcnt vmcnt(13)
    buffer_load_dwordx4 v[140:143], v246, s[16:19], s30 offen offset:0 nt
    s_waitcnt vmcnt(13)
    buffer_load_dwordx4 v[144:147], v241, s[16:19], s30 offen offset:0 nt
    s_waitcnt vmcnt(13)
    buffer_load_dwordx4 v[148:151], v243, s[16:19], s30 offen offset:0 nt
    s_waitcnt vmcnt(13)
    buffer_load_dwordx4 v[152:155], v245, s[16:19], s30 offen offset:0 nt
    s_waitcnt vmcnt(13)
    buffer_load_dwordx4 v[156:159], v247, s[16:19], s30 offen offset:0 nt
    s_waitcnt vmcnt(13)
    buffer_load_dwordx4 v[160:163], v240, s[12:15], s31 offen offset:0 nt
    s_waitcnt vmcnt(13)
    buffer_load_dwordx4 v[164:167], v242, s[12:15], s31 offen offset:0 nt
    s_waitcnt vmcnt(13)
    buffer_load_dwordx4 v[168:171], v244, s[12:15], s31 offen offset:0 nt
    s_waitcnt vmcnt(13)
    buffer_load_dwordx4 v[172:175], v246, s[12:15], s31 offen offset:0 nt
    s_waitcnt vmcnt(13)
    buffer_load_dwordx4 v[176:179], v241, s[12:15], s31 offen offset:0 nt
    s_waitcnt vmcnt(13)
    buffer_load_dwordx4 v[180:183], v243, s[12:15], s31 offen offset:0 nt
    s_waitcnt vmcnt(13)
    buffer_load_dwordx4 v[184:187], v245, s[12:15], s31 offen offset:0 nt
    s_waitcnt vmcnt(13)
    buffer_load_dwordx4 v[188:191], v247, s[12:15], s31 offen offset:0 nt
    s_waitcnt vmcnt(13)
    buffer_load_dwordx4 v[192:195], v240, s[16:19], s31 offen offset:0 nt
    s_waitcnt vmcnt(13)
    buffer_load_dwordx4 v[196:199], v242, s[16:19], s31 offen offset:0 nt
    s_waitcnt vmcnt(13)
    buffer_load_dwordx4 v[200:203], v244, s[16:19], s31 offen offset:0 nt
    s_waitcnt vmcnt(13)
    buffer_load_dwordx4 v[204:207], v246, s[16:19], s31 offen offset:0 nt
    s_waitcnt vmcnt(13)
    buffer_load_dwordx4 v[208:211], v241, s[16:19], s31 offen offset:0 nt
    s_waitcnt vmcnt(13)
    buffer_load_dwordx4 v[212:215], v243, s[16:19], s31 offen offset:0 nt
    s_waitcnt vmcnt(13)
    buffer_load_dwordx4 v[216:219], v245, s[16:19], s31 offen offset:0 nt
    s_waitcnt vmcnt(13)
    buffer_load_dwordx4 v[220:223], v247, s[16:19], s31 offen offset:0 nt
    v_mov_b32 v28, 151652
    s_mov_b32 s29, 1600000
L_wl_52:
    ds_read_b32 v29, v28
    s_sub_u32 s29, s29, 1
    s_cbranch_scc1 L_wl_52_x
    s_waitcnt lgkmcnt(0)
    v_readfirstlane_b32 s28, v29
    s_cmp_ge_u32 s28, 1
    s_nop 2
    s_cbranch_scc1 L_wl_52_x
    s_sleep 1
    s_branch L_wl_52
L_wl_52_x:
    s_waitcnt lgkmcnt(0)
    ds_read_b128 v[8:11], v6
    ds_read_b128 v[12:15], v7
    v_mov_b32 v28, 151664
    s_mov_b32 s29, 1600000
L_wl_53:
    ds_read_b32 v29, v28
    s_sub_u32 s29, s29, 1
    s_cbranch_scc1 L_wl_53_x
    s_waitcnt lgkmcnt(0)
    v_readfirstlane_b32 s28, v29
    s_cmp_ge_u32 s28, 1
    s_nop 2
    s_cbranch_scc1 L_wl_53_x
    s_sleep 1
    s_branch L_wl_53
L_wl_53_x:
    s_waitcnt lgkmcnt(0)
    ds_read_b32 v29, v28 offset:4
    s_waitcnt lgkmcnt(0)
    v_readfirstlane_b32 s63, v29
    s_waitcnt lgkmcnt(0)
L_aloop_54:
    s_waitcnt vmcnt(16)
    v_readfirstlane_b32 s30, v224
    s_add_u32 s28, s30, 1
    s_cmp_ge_i32 s28, s32
    s_nop 1
    s_cbranch_scc1 L_aeA_55
    s_cmp_eq_u32 s34, 0
    s_cbranch_scc1 L_aeA_55
    s_cmp_lt_i32 s28, s35
    s_cselect_b32 s34, 1, 0
    s_add_u32 s30, s28, s33
    s_and_b32 s30, s30, 127
    s_mov_b32 s29, 0
    s_bfe_u32 s57, s30, 327680
    s_lshl_b32 s57, s57, 8
    s_or_b32 s29, s29, s57
    s_bfe_u32 s57, s30, 65541
    s_lshl_b32 s57, s57, 14
    s_or_b32 s29, s29, s57
    s_bfe_u32 s57, s30, 65542
    s_lshl_b32 s57, s57, 19
    s_or_b32 s29, s29, s57
    s_mov_b32 s30, s29
    s_add_u32 s30, s30, s49
    v_dot2_f32_bf16 v16, v96, v8, 0
    v_dot2_f32_bf16 v17, v100, v8, 0
    v_dot2_f32_bf16 v18, v104, v8, 0
    v_dot2_f32_bf16 v19, v108, v8, 0
    v_dot2c_f32_bf16 v16, v97, v9
    v_dot2c_f32_bf16 v17, v101, v9
    v_dot2c_f32_bf16 v18, v105, v9
    v_dot2c_f32_bf16 v19, v109, v9
    v_dot2c_f32_bf16 v16, v98, v10
    v_dot2c_f32_bf16 v17, v102, v10
    v_dot2c_f32_bf16 v18, v106, v10
    v_dot2c_f32_bf16 v19, v110, v10
    v_dot2c_f32_bf16 v16, v99, v11
    v_dot2c_f32_bf16 v17, v103, v11
    v_dot2c_f32_bf16 v18, v107, v11
    v_dot2c_f32_bf16 v19, v111, v11
    v_dot2c_f32_bf16_dpp v16, v96, v12 quad_perm:[1,0,3,2] row_mask:0xf bank_mask:0xf
    v_dot2c_f32_bf16_dpp v17, v100, v12 quad_perm:[1,0,3,2] row_mask:0xf bank_mask:0xf
    v_dot2c_f32_bf16_dpp v18, v104, v12 quad_perm:[1,0,3,2] row_mask:0xf bank_mask:0xf
    v_dot2c_f32_bf16_dpp v19, v108, v12 quad_perm:[1,0,3,2] row_mask:0xf bank_mask:0xf
    v_dot2c_f32_bf16_dpp v16, v97, v13 quad_perm:[1,0,3,2] row_mask:0xf bank_mask:0xf
    v_dot2c_f32_bf16_dpp v17, v101, v13 quad_perm:[1,0,3,2] row_mask:0xf bank_mask:0xf
    v_dot2c_f32_bf16_dpp v18, v105, v13 quad_perm:[1,0,3,2] row_mask:0xf bank_mask:0xf
    v_dot2c_f32_bf16_dpp v19, v109, v13 quad_perm:[1,0,3,2] row_mask:0xf bank_mask:0xf
    v_dot2c_f32_bf16_dpp v16, v98, v14 quad_perm:[1,0,3,2] row_mask:0xf bank_mask:0xf
    v_dot2c_f32_bf16_dpp v17, v102, v14 quad_perm:[1,0,3,2] row_mask:0xf bank_mask:0xf
    v_dot2c_f32_bf16_dpp v18, v106, v14 quad_perm:[1,0,3,2] row_mask:0xf bank_mask:0xf
    v_dot2c_f32_bf16_dpp v19, v110, v14 quad_perm:[1,0,3,2] row_mask:0xf bank_mask:0xf
    v_dot2c_f32_bf16_dpp v16, v99, v15 quad_perm:[1,0,3,2] row_mask:0xf bank_mask:0xf
    v_dot2c_f32_bf16_dpp v17, v103, v15 quad_perm:[1,0,3,2] row_mask:0xf bank_mask:0xf
    v_dot2c_f32_bf16_dpp v18, v107, v15 quad_perm:[1,0,3,2] row_mask:0xf bank_mask:0xf
    v_dot2c_f32_bf16_dpp v19, v111, v15 quad_perm:[1,0,3,2] row_mask:0xf bank_mask:0xf
    v_mov_b32 v224, s34
    s_mov_b64 exec, 1
    buffer_atomic_add v224, v226, s[4:7], s48 offen sc0 sc1
    s_mov_b64 exec, -1
    s_waitcnt vmcnt(13)
    buffer_load_dwordx4 v[96:99], v240, s[12:15], s30 offen offset:0 nt
    s_waitcnt vmcnt(13)
    buffer_load_dwordx4 v[100:103], v242, s[12:15], s30 offen offset:0 nt
    s_waitcnt vmcnt(13)
    buffer_load_dwordx4 v[104:107], v244, s[12:15], s30 offen offset:0 nt
    s_waitcnt vmcnt(13)
    buffer_load_dwordx4 v[108:111], v246, s[12:15], s30 offen offset:0 nt
    v_dot2_f32_bf16 v20, v112, v8, 0
    v_dot2_f32_bf16 v21, v116, v8, 0
    v_dot2_f32_bf16 v22, v120, v8, 0
    v_dot2_f32_bf16 v23, v124, v8, 0
    v_dot2c_f32_bf16 v20, v113, v9
    v_dot2c_f32_bf16 v21, v117, v9
    v_dot2c_f32_bf16 v22, v121, v9
    v_dot2c_f32_bf16 v23, v125, v9
    v_dot2c_f32_bf16 v20, v114, v10
    v_dot2c_f32_bf16 v21, v118, v10
    v_dot2c_f32_bf16 v22, v122, v10
    v_dot2c_f32_bf16 v23, v126, v10
    v_dot2c_f32_bf16 v20, v115, v11
    v_dot2c_f32_bf16 v21, v119, v11
    v_dot2c_f32_bf16 v22, v123, v11
    v_dot2c_f32_bf16 v23, v127, v11
    v_dot2c_f32_bf16_dpp v20, v112, v12 quad_perm:[1,0,3,2] row_mask:0xf bank_mask:0xf
    v_dot2c_f32_bf16_dpp v21, v116, v12 quad_perm:[1,0,3,2] row_mask:0xf bank_mask:0xf
    v_dot2c_f32_bf16_dpp v22, v120, v12 quad_perm:[1,0,3,2] row_mask:0xf bank_mask:0xf
    v_dot2c_f32_bf16_dpp v23, v124, v12 quad_perm:[1,0,3,2] row_mask:0xf bank_mask:0xf
    v_dot2c_f32_bf16_dpp v20, v113, v13 quad_perm:[1,0,3,2] row_mask:0xf bank_mask:0xf
    v_dot2c_f32_bf16_dpp v21, v117, v13 quad_perm:[1,0,3,2] row_mask:0xf bank_mask:0xf
    v_dot2c_f32_bf16_dpp v22, v121, v13 quad_perm:[1,0,3,2] row_mask:0xf bank_mask:0xf
    v_dot2c_f32_bf16_dpp v23, v125, v13 quad_perm:[1,0,3,2] row_mask:0xf bank_mask:0xf
    v_dot2c_f32_bf16_dpp v20, v114, v14 quad_perm:[1,0,3,2] row_mask:0xf bank_mask:0xf
    v_dot2c_f32_bf16_dpp v21, v118, v14 quad_perm:[1,0,3,2] row_mask:0xf bank_mask:0xf
    v_dot2c_f32_bf16_dpp v22, v122, v14 quad_perm:[1,0,3,2] row_mask:0xf bank_mask:0xf
    v_dot2c_f32_bf16_dpp v23, v126, v14 quad_perm:[1,0,3,2] row_mask:0xf bank_mask:0xf
    v_dot2c_f32_bf16_dpp v20, v115, v15 quad_perm:[1,0,3,2] row_mask:0xf bank_mask:0xf
    v_dot2c_f32_bf16_dpp v21, v119, v15 quad_perm:[1,0,3,2] row_mask:0xf bank_mask:0xf
    v_dot2c_f32_bf16_dpp v22, v123, v15 quad_perm:[1,0,3,2] row_mask:0xf bank_mask:0xf
    v_dot2c_f32_bf16_dpp v23, v127, v15 quad_perm:[1,0,3,2] row_mask:0xf bank_mask:0xf
    s_waitcnt vmcnt(13)
    buffer_load_dwordx4 v[112:115], v241, s[12:15], s30 offen offset:0 nt
    s_waitcnt vmcnt(13)
    buffer_load_dwordx4 v[116:119], v243, s[12:15], s30 offen offset:0 nt
    s_waitcnt vmcnt(13)
    buffer_load_dwordx4 v[120:123], v245, s[12:15], s30 offen offset:0 nt
    s_waitcnt vmcnt(13)
    buffer_load_dwordx4 v[124:127], v247, s[12:15], s30 offen offset:0 nt
    v_add_f32_dpp v16, v16, v16 quad_perm:[2,3,0,1] row_mask:0xf bank_mask:0xf
    v_add_f32_dpp v17, v17, v17 quad_perm:[2,3,0,1] row_mask:0xf bank_mask:0xf
    v_add_f32_dpp v18, v18, v18 quad_perm:[2,3,0,1] row_mask:0xf bank_mask:0xf
    v_add_f32_dpp v19, v19, v19 quad_perm:[2,3,0,1] row_mask:0xf bank_mask:0xf
    v_add_f32_dpp v20, v20, v20 quad_perm:[2,3,0,1] row_mask:0xf bank_mask:0xf
    v_add_f32_dpp v21, v21, v21 quad_perm:[2,3,0,1] row_mask:0xf bank_mask:0xf
    v_add_f32_dpp v22, v22, v22 quad_perm:[2,3,0,1] row_mask:0xf bank_mask:0xf
    v_add_f32_dpp v23, v23, v23 quad_perm:[2,3,0,1] row_mask:0xf bank_mask:0xf
    v_add_f32_dpp v16, v16, v16 row_ror:4 row_mask:0xf bank_mask:0xf
    v_add_f32_dpp v17, v17, v17 row_ror:4 row_mask:0xf bank_mask:0xf
    v_add_f32_dpp v18, v18, v18 row_ror:4 row_mask:0xf bank_mask:0xf
    v_add_f32_dpp v19, v19, v19 row_ror:4 row_mask:0xf bank_mask:0xf
    v_add_f32_dpp v20, v20, v20 row_ror:4 row_mask:0xf bank_mask:0xf
    v_add_f32_dpp v21, v21, v21 row_ror:4 row_mask:0xf bank_mask:0xf
    v_add_f32_dpp v22, v22, v22 row_ror:4 row_mask:0xf bank_mask:0xf
    v_add_f32_dpp v23, v23, v23 row_ror:4 row_mask:0xf bank_mask:0xf
    v_add_f32_dpp v16, v16, v16 row_ror:8 row_mask:0xf bank_mask:0xf
    v_add_f32_dpp v17, v17, v17 row_ror:8 row_mask:0xf bank_mask:0xf
    v_add_f32_dpp v18, v18, v18 row_ror:8 row_mask:0xf bank_mask:0xf
    v_add_f32_dpp v19, v19, v19 row_ror:8 row_mask:0xf bank_mask:0xf
    v_add_f32_dpp v20, v20, v20 row_ror:8 row_mask:0xf bank_mask:0xf
    v_add_f32_dpp v21, v21, v21 row_ror:8 row_mask:0xf bank_mask:0xf
    v_add_f32_dpp v22, v22, v22 row_ror:8 row_mask:0xf bank_mask:0xf
    v_add_f32_dpp v23, v23, v23 row_ror:8 row_mask:0xf bank_mask:0xf
    v_mul_f32 v16, v16, v3
    v_mul_f32 v17, v17, v3
    v_mul_f32 v18, v18, v3
    v_mul_f32 v19, v19, v3
    v_mul_f32 v20, v20, v3
    v_mul_f32 v21, v21, v3
    v_mul_f32 v22, v22, v3
    v_mul_f32 v23, v23, v3
    v_max3_f32 v28, v16, v17, v18
    v_max3_f32 v28, v28, v19, v20
    v_max3_f32 v28, v28, v21, v22
    v_max3_f32 v28, v28, v23, v4
    v_mov_b32 v29, v28
    s_nop 1
    v_permlane16_swap_b32 v28, v29
    v_max_f32 v28, v28, v29
    v_mov_b32 v29, v28
    s_nop 1
    v_permlane32_swap_b32 v28, v29
    v_max_f32 v28, v28, v29
    v_sub_f32 v29, v4, v28
    v_sub_f32 v16, v16, v28
    v_sub_f32 v17, v17, v28
    v_sub_f32 v18, v18, v28
    v_sub_f32 v19, v19, v28
    v_sub_f32 v20, v20, v28
    v_sub_f32 v21, v21, v28
    v_sub_f32 v22, v22, v28
    v_sub_f32 v23, v23, v28
    v_exp_f32 v29, v29
    v_exp_f32 v16, v16
    v_exp_f32 v17, v17
    v_exp_f32 v18, v18
    v_exp_f32 v19, v19
    v_exp_f32 v20, v20
    v_exp_f32 v21, v21
    v_exp_f32 v22, v22
    v_exp_f32 v23, v23
    v_mov_b32 v4, v28
    v_cmp_neq_f32 vcc, 1.0, v29
    v_fma_f32 v5, v5, v29, v16
    v_add_f32 v30, v17, v18
    v_add_f32 v31, v19, v20
    v_add_f32 v5, v5, v21
    v_add_f32 v30, v30, v22
    v_add_f32 v31, v31, v23
    v_add_f32 v5, v5, v30
    v_add_f32 v5, v5, v31
    v_cvt_pk_bf16_f32 v24, v16, v17
    v_cvt_pk_bf16_f32 v25, v18, v19
    v_cvt_pk_bf16_f32 v26, v20, v21
    v_cvt_pk_bf16_f32 v27, v22, v23
    s_nop 0
    s_cbranch_vccz L_nors_58
    v_mul_f32 v32, v29, v32
    v_mul_f32 v33, v29, v33
    v_mul_f32 v34, v29, v34
    v_mul_f32 v35, v29, v35
    v_mul_f32 v36, v29, v36
    v_mul_f32 v37, v29, v37
    v_mul_f32 v38, v29, v38
    v_mul_f32 v39, v29, v39
    v_mul_f32 v40, v29, v40
    v_mul_f32 v41, v29, v41
    v_mul_f32 v42, v29, v42
    v_mul_f32 v43, v29, v43
    v_mul_f32 v44, v29, v44
    v_mul_f32 v45, v29, v45
    v_mul_f32 v46, v29, v46
    v_mul_f32 v47, v29, v47
    v_mul_f32 v48, v29, v48
    v_mul_f32 v49, v29, v49
    v_mul_f32 v50, v29, v50
    v_mul_f32 v51, v29, v51
    v_mul_f32 v52, v29, v52
    v_mul_f32 v53, v29, v53
    v_mul_f32 v54, v29, v54
    v_mul_f32 v55, v29, v55
    v_mul_f32 v56, v29, v56
    v_mul_f32 v57, v29, v57
    v_mul_f32 v58, v29, v58
    v_mul_f32 v59, v29, v59
    v_mul_f32 v60, v29, v60
    v_mul_f32 v61, v29, v61
    v_mul_f32 v62, v29, v62
    v_mul_f32 v63, v29, v63
L_nors_58:
    v_perm_b32 v64, v132, v128, s50
    v_perm_b32 v68, v132, v128, s51
    v_perm_b32 v72, v133, v129, s50
    v_perm_b32 v76, v133, v129, s51
    v_perm_b32 v80, v134, v130, s50
    v_perm_b32 v84, v134, v130, s51
    v_perm_b32 v88, v135, v131, s50
    v_perm_b32 v92, v135, v131, s51
    s_waitcnt vmcnt(13)
    buffer_load_dwordx4 v[128:131], v240, s[16:19], s30 offen offset:0 nt
    s_waitcnt vmcnt(13)
    buffer_load_dwordx4 v[132:135], v242, s[16:19], s30 offen offset:0 nt
    v_perm_b32 v65, v140, v136, s50
    v_perm_b32 v69, v140, v136, s51
    v_perm_b32 v73, v141, v137, s50
    v_perm_b32 v77, v141, v137, s51
    v_perm_b32 v81, v142, v138, s50
    v_perm_b32 v85, v142, v138, s51
    v_perm_b32 v89, v143, v139, s50
    v_perm_b32 v93, v143, v139, s51
    s_waitcnt vmcnt(13)
    buffer_load_dwordx4 v[136:139], v244, s[16:19], s30 offen offset:0 nt
    s_waitcnt vmcnt(13)
    buffer_load_dwordx4 v[140:143], v246, s[16:19], s30 offen offset:0 nt
    v_perm_b32 v66, v148, v144, s50
    v_perm_b32 v70, v148, v144, s51
    v_perm_b32 v74, v149, v145, s50
    v_perm_b32 v78, v149, v145, s51
    v_perm_b32 v82, v150, v146, s50
    v_perm_b32 v86, v150, v146, s51
    v_perm_b32 v90, v151, v147, s50
    v_perm_b32 v94, v151, v147, s51
    s_waitcnt vmcnt(13)
    buffer_load_dwordx4 v[144:147], v241, s[16:19], s30 offen offset:0 nt
    s_waitcnt vmcnt(13)
    buffer_load_dwordx4 v[148:151], v243, s[16:19], s30 offen offset:0 nt
    v_perm_b32 v67, v156, v152, s50
    v_perm_b32 v71, v156, v152, s51
    v_perm_b32 v75, v157, v153, s50
    v_perm_b32 v79, v157, v153, s51
    v_perm_b32 v83, v158, v154, s50
    v_perm_b32 v87, v158, v154, s51
    v_perm_b32 v91, v159, v155, s50
    v_perm_b32 v95, v159, v155, s51
    s_waitcnt vmcnt(13)
    buffer_load_dwordx4 v[152:155], v245, s[16:19], s30 offen offset:0 nt
    s_waitcnt vmcnt(13)
    buffer_load_dwordx4 v[156:159], v247, s[16:19], s30 offen offset:0 nt
    v_mfma_f32_16x16x32_bf16 v[32:35], v[64:67], v[24:27], v[32:35]
    v_mfma_f32_16x16x32_bf16 v[36:39], v[68:71], v[24:27], v[36:39]
    v_mfma_f32_16x16x32_bf16 v[40:43], v[72:75], v[24:27], v[40:43]
    v_mfma_f32_16x16x32_bf16 v[44:47], v[76:79], v[24:27], v[44:47]
    v_mfma_f32_16x16x32_bf16 v[48:51], v[80:83], v[24:27], v[48:51]
    v_mfma_f32_16x16x32_bf16 v[52:55], v[84:87], v[24:27], v[52:55]
    v_mfma_f32_16x16x32_bf16 v[56:59], v[88:91], v[24:27], v[56:59]
    v_mfma_f32_16x16x32_bf16 v[60:63], v[92:95], v[24:27], v[60:63]
    s_waitcnt vmcnt(16)
    v_readfirstlane_b32 s30, v224
    s_add_u32 s28, s30, 1
    s_cmp_ge_i32 s28, s32
    s_nop 2
    s_cbranch_scc1 L_aeB_56
    s_cmp_eq_u32 s34, 0
    s_cbranch_scc1 L_aeB_56
    s_cmp_lt_i32 s28, s35
    s_cselect_b32 s34, 1, 0
    s_add_u32 s30, s28, s33
    s_and_b32 s30, s30, 127
    s_mov_b32 s29, 0
    s_bfe_u32 s57, s30, 327680
    s_lshl_b32 s57, s57, 8
    s_or_b32 s29, s29, s57
    s_bfe_u32 s57, s30, 65541
    s_lshl_b32 s57, s57, 14
    s_or_b32 s29, s29, s57
    s_bfe_u32 s57, s30, 65542
    s_lshl_b32 s57, s57, 19
    s_or_b32 s29, s29, s57
    s_mov_b32 s30, s29
    s_add_u32 s30, s30, s49
    v_dot2_f32_bf16 v16, v160, v8, 0
    v_dot2_f32_bf16 v17, v164, v8, 0
    v_dot2_f32_bf16 v18, v168, v8, 0
    v_dot2_f32_bf16 v19, v172, v8, 0
    v_dot2c_f32_bf16 v16, v161, v9
    v_dot2c_f32_bf16 v17, v165, v9
    v_dot2c_f32_bf16 v18, v169, v9
    v_dot2c_f32_bf16 v19, v173, v9
    v_dot2c_f32_bf16 v16, v162, v10
    v_dot2c_f32_bf16 v17, v166, v10
    v_dot2c_f32_bf16 v18, v170, v10
    v_dot2c_f32_bf16 v19, v174, v10
    v_dot2c_f32_bf16 v16, v163, v11
    v_dot2c_f32_bf16 v17, v167, v11
    v_dot2c_f32_bf16 v18, v171, v11
    v_dot2c_f32_bf16 v19, v175, v11
    v_dot2c_f32_bf16_dpp v16, v160, v12 quad_perm:[1,0,3,2] row_mask:0xf bank_mask:0xf
    v_dot2c_f32_bf16_dpp v17, v164, v12 quad_perm:[1,0,3,2] row_mask:0xf bank_mask:0xf
    v_dot2c_f32_bf16_dpp v18, v168, v12 quad_perm:[1,0,3,2] row_mask:0xf bank_mask:0xf
    v_dot2c_f32_bf16_dpp v19, v172, v12 quad_perm:[1,0,3,2] row_mask:0xf bank_mask:0xf
    v_dot2c_f32_bf16_dpp v16, v161, v13 quad_perm:[1,0,3,2] row_mask:0xf bank_mask:0xf
    v_dot2c_f32_bf16_dpp v17, v165, v13 quad_perm:[1,0,3,2] row_mask:0xf bank_mask:0xf
    v_dot2c_f32_bf16_dpp v18, v169, v13 quad_perm:[1,0,3,2] row_mask:0xf bank_mask:0xf
    v_dot2c_f32_bf16_dpp v19, v173, v13 quad_perm:[1,0,3,2] row_mask:0xf bank_mask:0xf
    v_dot2c_f32_bf16_dpp v16, v162, v14 quad_perm:[1,0,3,2] row_mask:0xf bank_mask:0xf
    v_dot2c_f32_bf16_dpp v17, v166, v14 quad_perm:[1,0,3,2] row_mask:0xf bank_mask:0xf
    v_dot2c_f32_bf16_dpp v18, v170, v14 quad_perm:[1,0,3,2] row_mask:0xf bank_mask:0xf
    v_dot2c_f32_bf16_dpp v19, v174, v14 quad_perm:[1,0,3,2] row_mask:0xf bank_mask:0xf
    v_dot2c_f32_bf16_dpp v16, v163, v15 quad_perm:[1,0,3,2] row_mask:0xf bank_mask:0xf
    v_dot2c_f32_bf16_dpp v17, v167, v15 quad_perm:[1,0,3,2] row_mask:0xf bank_mask:0xf
    v_dot2c_f32_bf16_dpp v18, v171, v15 quad_perm:[1,0,3,2] row_mask:0xf bank_mask:0xf
    v_dot2c_f32_bf16_dpp v19, v175, v15 quad_perm:[1,0,3,2] row_mask:0xf bank_mask:0xf
    v_mov_b32 v224, s34
    s_mov_b64 exec, 1
    buffer_atomic_add v224, v226, s[4:7], s48 offen sc0 sc1
    s_mov_b64 exec, -1
    s_waitcnt vmcnt(13)
    buffer_load_dwordx4 v[160:163], v240, s[12:15], s30 offen offset:0 nt
    s_waitcnt vmcnt(13)
    buffer_load_dwordx4 v[164:167], v242, s[12:15], s30 offen offset:0 nt
    s_waitcnt vmcnt(13)
    buffer_load_dwordx4 v[168:171], v244, s[12:15], s30 offen offset:0 nt
    s_waitcnt vmcnt(13)
    buffer_load_dwordx4 v[172:175], v246, s[12:15], s30 offen offset:0 nt
    v_dot2_f32_bf16 v20, v176, v8, 0
    v_dot2_f32_bf16 v21, v180, v8, 0
    v_dot2_f32_bf16 v22, v184, v8, 0
    v_dot2_f32_bf16 v23, v188, v8, 0
    v_dot2c_f32_bf16 v20, v177, v9
    v_dot2c_f32_bf16 v21, v181, v9
    v_dot2c_f32_bf16 v22, v185, v9
    v_dot2c_f32_bf16 v23, v189, v9
    v_dot2c_f32_bf16 v20, v178, v10
    v_dot2c_f32_bf16 v21, v182, v10
    v_dot2c_f32_bf16 v22, v186, v10
    v_dot2c_f32_bf16 v23, v190, v10
    v_dot2c_f32_bf16 v20, v179, v11
    v_dot2c_f32_bf16 v21, v183, v11
    v_dot2c_f32_bf16 v22, v187, v11
    v_dot2c_f32_bf16 v23, v191, v11
    v_dot2c_f32_bf16_dpp v20, v176, v12 quad_perm:[1,0,3,2] row_mask:0xf bank_mask:0xf
    v_dot2c_f32_bf16_dpp v21, v180, v12 quad_perm:[1,0,3,2] row_mask:0xf bank_mask:0xf
    v_dot2c_f32_bf16_dpp v22, v184, v12 quad_perm:[1,0,3,2] row_mask:0xf bank_mask:0xf
    v_dot2c_f32_bf16_dpp v23, v188, v12 quad_perm:[1,0,3,2] row_mask:0xf bank_mask:0xf
    v_dot2c_f32_bf16_dpp v20, v177, v13 quad_perm:[1,0,3,2] row_mask:0xf bank_mask:0xf
    v_dot2c_f32_bf16_dpp v21, v181, v13 quad_perm:[1,0,3,2] row_mask:0xf bank_mask:0xf
    v_dot2c_f32_bf16_dpp v22, v185, v13 quad_perm:[1,0,3,2] row_mask:0xf bank_mask:0xf
    v_dot2c_f32_bf16_dpp v23, v189, v13 quad_perm:[1,0,3,2] row_mask:0xf bank_mask:0xf
    v_dot2c_f32_bf16_dpp v20, v178, v14 quad_perm:[1,0,3,2] row_mask:0xf bank_mask:0xf
    v_dot2c_f32_bf16_dpp v21, v182, v14 quad_perm:[1,0,3,2] row_mask:0xf bank_mask:0xf
    v_dot2c_f32_bf16_dpp v22, v186, v14 quad_perm:[1,0,3,2] row_mask:0xf bank_mask:0xf
    v_dot2c_f32_bf16_dpp v23, v190, v14 quad_perm:[1,0,3,2] row_mask:0xf bank_mask:0xf
    v_dot2c_f32_bf16_dpp v20, v179, v15 quad_perm:[1,0,3,2] row_mask:0xf bank_mask:0xf
    v_dot2c_f32_bf16_dpp v21, v183, v15 quad_perm:[1,0,3,2] row_mask:0xf bank_mask:0xf
    v_dot2c_f32_bf16_dpp v22, v187, v15 quad_perm:[1,0,3,2] row_mask:0xf bank_mask:0xf
    v_dot2c_f32_bf16_dpp v23, v191, v15 quad_perm:[1,0,3,2] row_mask:0xf bank_mask:0xf
    s_waitcnt vmcnt(13)
    buffer_load_dwordx4 v[176:179], v241, s[12:15], s30 offen offset:0 nt
    s_waitcnt vmcnt(13)
    buffer_load_dwordx4 v[180:183], v243, s[12:15], s30 offen offset:0 nt
    s_waitcnt vmcnt(13)
    buffer_load_dwordx4 v[184:187], v245, s[12:15], s30 offen offset:0 nt
    s_waitcnt vmcnt(13)
    buffer_load_dwordx4 v[188:191], v247, s[12:15], s30 offen offset:0 nt
    v_add_f32_dpp v16, v16, v16 quad_perm:[2,3,0,1] row_mask:0xf bank_mask:0xf
    v_add_f32_dpp v17, v17, v17 quad_perm:[2,3,0,1] row_mask:0xf bank_mask:0xf
    v_add_f32_dpp v18, v18, v18 quad_perm:[2,3,0,1] row_mask:0xf bank_mask:0xf
    v_add_f32_dpp v19, v19, v19 quad_perm:[2,3,0,1] row_mask:0xf bank_mask:0xf
    v_add_f32_dpp v20, v20, v20 quad_perm:[2,3,0,1] row_mask:0xf bank_mask:0xf
    v_add_f32_dpp v21, v21, v21 quad_perm:[2,3,0,1] row_mask:0xf bank_mask:0xf
    v_add_f32_dpp v22, v22, v22 quad_perm:[2,3,0,1] row_mask:0xf bank_mask:0xf
    v_add_f32_dpp v23, v23, v23 quad_perm:[2,3,0,1] row_mask:0xf bank_mask:0xf
    v_add_f32_dpp v16, v16, v16 row_ror:4 row_mask:0xf bank_mask:0xf
    v_add_f32_dpp v17, v17, v17 row_ror:4 row_mask:0xf bank_mask:0xf
    v_add_f32_dpp v18, v18, v18 row_ror:4 row_mask:0xf bank_mask:0xf
    v_add_f32_dpp v19, v19, v19 row_ror:4 row_mask:0xf bank_mask:0xf
    v_add_f32_dpp v20, v20, v20 row_ror:4 row_mask:0xf bank_mask:0xf
    v_add_f32_dpp v21, v21, v21 row_ror:4 row_mask:0xf bank_mask:0xf
    v_add_f32_dpp v22, v22, v22 row_ror:4 row_mask:0xf bank_mask:0xf
    v_add_f32_dpp v23, v23, v23 row_ror:4 row_mask:0xf bank_mask:0xf
    v_add_f32_dpp v16, v16, v16 row_ror:8 row_mask:0xf bank_mask:0xf
    v_add_f32_dpp v17, v17, v17 row_ror:8 row_mask:0xf bank_mask:0xf
    v_add_f32_dpp v18, v18, v18 row_ror:8 row_mask:0xf bank_mask:0xf
    v_add_f32_dpp v19, v19, v19 row_ror:8 row_mask:0xf bank_mask:0xf
    v_add_f32_dpp v20, v20, v20 row_ror:8 row_mask:0xf bank_mask:0xf
    v_add_f32_dpp v21, v21, v21 row_ror:8 row_mask:0xf bank_mask:0xf
    v_add_f32_dpp v22, v22, v22 row_ror:8 row_mask:0xf bank_mask:0xf
    v_add_f32_dpp v23, v23, v23 row_ror:8 row_mask:0xf bank_mask:0xf
    v_mul_f32 v16, v16, v3
    v_mul_f32 v17, v17, v3
    v_mul_f32 v18, v18, v3
    v_mul_f32 v19, v19, v3
    v_mul_f32 v20, v20, v3
    v_mul_f32 v21, v21, v3
    v_mul_f32 v22, v22, v3
    v_mul_f32 v23, v23, v3
    v_max3_f32 v28, v16, v17, v18
    v_max3_f32 v28, v28, v19, v20
    v_max3_f32 v28, v28, v21, v22
    v_max3_f32 v28, v28, v23, v4
    v_mov_b32 v29, v28
    s_nop 1
    v_permlane16_swap_b32 v28, v29
    v_max_f32 v28, v28, v29
    v_mov_b32 v29, v28
    s_nop 1
    v_permlane32_swap_b32 v28, v29
    v_max_f32 v28, v28, v29
    v_sub_f32 v29, v4, v28
    v_sub_f32 v16, v16, v28
    v_sub_f32 v17, v17, v28
    v_sub_f32 v18, v18, v28
    v_sub_f32 v19, v19, v28
    v_sub_f32 v20, v20, v28
    v_sub_f32 v21, v21, v28
    v_sub_f32 v22, v22, v28
    v_sub_f32 v23, v23, v28
    v_exp_f32 v29, v29
    v_exp_f32 v16, v16
    v_exp_f32 v17, v17
    v_exp_f32 v18, v18
    v_exp_f32 v19, v19
    v_exp_f32 v20, v20
    v_exp_f32 v21, v21
    v_exp_f32 v22, v22
    v_exp_f32 v23, v23
    v_mov_b32 v4, v28
    v_cmp_neq_f32 vcc, 1.0, v29
    v_fma_f32 v5, v5, v29, v16
    v_add_f32 v30, v17, v18
    v_add_f32 v31, v19, v20
    v_add_f32 v5, v5, v21
    v_add_f32 v30, v30, v22
    v_add_f32 v31, v31, v23
    v_add_f32 v5, v5, v30
    v_add_f32 v5, v5, v31
    v_cvt_pk_bf16_f32 v24, v16, v17
    v_cvt_pk_bf16_f32 v25, v18, v19
    v_cvt_pk_bf16_f32 v26, v20, v21
    v_cvt_pk_bf16_f32 v27, v22, v23
    s_nop 0
    s_cbranch_vccz L_nors_59
    v_mul_f32 v32, v29, v32
    v_mul_f32 v33, v29, v33
    v_mul_f32 v34, v29, v34
    v_mul_f32 v35, v29, v35
    v_mul_f32 v36, v29, v36
    v_mul_f32 v37, v29, v37
    v_mul_f32 v38, v29, v38
    v_mul_f32 v39, v29, v39
    v_mul_f32 v40, v29, v40
    v_mul_f32 v41, v29, v41
    v_mul_f32 v42, v29, v42
    v_mul_f32 v43, v29, v43
    v_mul_f32 v44, v29, v44
    v_mul_f32 v45, v29, v45
    v_mul_f32 v46, v29, v46
    v_mul_f32 v47, v29, v47
    v_mul_f32 v48, v29, v48
    v_mul_f32 v49, v29, v49
    v_mul_f32 v50, v29, v50
    v_mul_f32 v51, v29, v51
    v_mul_f32 v52, v29, v52
    v_mul_f32 v53, v29, v53
    v_mul_f32 v54, v29, v54
    v_mul_f32 v55, v29, v55
    v_mul_f32 v56, v29, v56
    v_mul_f32 v57, v29, v57
    v_mul_f32 v58, v29, v58
    v_mul_f32 v59, v29, v59
    v_mul_f32 v60, v29, v60
    v_mul_f32 v61, v29, v61
    v_mul_f32 v62, v29, v62
    v_mul_f32 v63, v29, v63
L_nors_59:
    v_perm_b32 v64, v196, v192, s50
    v_perm_b32 v68, v196, v192, s51
    v_perm_b32 v72, v197, v193, s50
    v_perm_b32 v76, v197, v193, s51
    v_perm_b32 v80, v198, v194, s50
    v_perm_b32 v84, v198, v194, s51
    v_perm_b32 v88, v199, v195, s50
    v_perm_b32 v92, v199, v195, s51
    s_waitcnt vmcnt(13)
    buffer_load_dwordx4 v[192:195], v240, s[16:19], s30 offen offset:0 nt
    s_waitcnt vmcnt(13)
    buffer_load_dwordx4 v[196:199], v242, s[16:19], s30 offen offset:0 nt
    v_perm_b32 v65, v204, v200, s50
    v_perm_b32 v69, v204, v200, s51
    v_perm_b32 v73, v205, v201, s50
    v_perm_b32 v77, v205, v201, s51
    v_perm_b32 v81, v206, v202, s50
    v_perm_b32 v85, v206, v202, s51
    v_perm_b32 v89, v207, v203, s50
    v_perm_b32 v93, v207, v203, s51
    s_waitcnt vmcnt(13)
    buffer_load_dwordx4 v[200:203], v244, s[16:19], s30 offen offset:0 nt
    s_waitcnt vmcnt(13)
    buffer_load_dwordx4 v[204:207], v246, s[16:19], s30 offen offset:0 nt
    v_perm_b32 v66, v212, v208, s50
    v_perm_b32 v70, v212, v208, s51
    v_perm_b32 v74, v213, v209, s50
    v_perm_b32 v78, v213, v209, s51
    v_perm_b32 v82, v214, v210, s50
    v_perm_b32 v86, v214, v210, s51
    v_perm_b32 v90, v215, v211, s50
    v_perm_b32 v94, v215, v211, s51
    s_waitcnt vmcnt(13)
    buffer_load_dwordx4 v[208:211], v241, s[16:19], s30 offen offset:0 nt
    s_waitcnt vmcnt(13)
    buffer_load_dwordx4 v[212:215], v243, s[16:19], s30 offen offset:0 nt
    v_perm_b32 v67, v220, v216, s50
    v_perm_b32 v71, v220, v216, s51
    v_perm_b32 v75, v221, v217, s50
    v_perm_b32 v79, v221, v217, s51
    v_perm_b32 v83, v222, v218, s50
    v_perm_b32 v87, v222, v218, s51
    v_perm_b32 v91, v223, v219, s50
    v_perm_b32 v95, v223, v219, s51
    s_waitcnt vmcnt(13)
    buffer_load_dwordx4 v[216:219], v245, s[16:19], s30 offen offset:0 nt
    s_waitcnt vmcnt(13)
    buffer_load_dwordx4 v[220:223], v247, s[16:19], s30 offen offset:0 nt
    v_mfma_f32_16x16x32_bf16 v[32:35], v[64:67], v[24:27], v[32:35]
    v_mfma_f32_16x16x32_bf16 v[36:39], v[68:71], v[24:27], v[36:39]
    v_mfma_f32_16x16x32_bf16 v[40:43], v[72:75], v[24:27], v[40:43]
    v_mfma_f32_16x16x32_bf16 v[44:47], v[76:79], v[24:27], v[44:47]
    v_mfma_f32_16x16x32_bf16 v[48:51], v[80:83], v[24:27], v[48:51]
    v_mfma_f32_16x16x32_bf16 v[52:55], v[84:87], v[24:27], v[52:55]
    v_mfma_f32_16x16x32_bf16 v[56:59], v[88:91], v[24:27], v[56:59]
    v_mfma_f32_16x16x32_bf16 v[60:63], v[92:95], v[24:27], v[60:63]
    s_nop 6
    s_branch L_aloop_54
L_aeA_55:
    v_dot2_f32_bf16 v16, v96, v8, 0
    v_dot2_f32_bf16 v17, v100, v8, 0
    v_dot2_f32_bf16 v18, v104, v8, 0
    v_dot2_f32_bf16 v19, v108, v8, 0
    v_dot2c_f32_bf16 v16, v97, v9
    v_dot2c_f32_bf16 v17, v101, v9
    v_dot2c_f32_bf16 v18, v105, v9
    v_dot2c_f32_bf16 v19, v109, v9
    v_dot2c_f32_bf16 v16, v98, v10
    v_dot2c_f32_bf16 v17, v102, v10
    v_dot2c_f32_bf16 v18, v106, v10
    v_dot2c_f32_bf16 v19, v110, v10
    v_dot2c_f32_bf16 v16, v99, v11
    v_dot2c_f32_bf16 v17, v103, v11
    v_dot2c_f32_bf16 v18, v107, v11
    v_dot2c_f32_bf16 v19, v111, v11
    v_dot2c_f32_bf16_dpp v16, v96, v12 quad_perm:[1,0,3,2] row_mask:0xf bank_mask:0xf
    v_dot2c_f32_bf16_dpp v17, v100, v12 quad_perm:[1,0,3,2] row_mask:0xf bank_mask:0xf
    v_dot2c_f32_bf16_dpp v18, v104, v12 quad_perm:[1,0,3,2] row_mask:0xf bank_mask:0xf
    v_dot2c_f32_bf16_dpp v19, v108, v12 quad_perm:[1,0,3,2] row_mask:0xf bank_mask:0xf
    v_dot2c_f32_bf16_dpp v16, v97, v13 quad_perm:[1,0,3,2] row_mask:0xf bank_mask:0xf
    v_dot2c_f32_bf16_dpp v17, v101, v13 quad_perm:[1,0,3,2] row_mask:0xf bank_mask:0xf
    v_dot2c_f32_bf16_dpp v18, v105, v13 quad_perm:[1,0,3,2] row_mask:0xf bank_mask:0xf
    v_dot2c_f32_bf16_dpp v19, v109, v13 quad_perm:[1,0,3,2] row_mask:0xf bank_mask:0xf
    v_dot2c_f32_bf16_dpp v16, v98, v14 quad_perm:[1,0,3,2] row_mask:0xf bank_mask:0xf
    v_dot2c_f32_bf16_dpp v17, v102, v14 quad_perm:[1,0,3,2] row_mask:0xf bank_mask:0xf
    v_dot2c_f32_bf16_dpp v18, v106, v14 quad_perm:[1,0,3,2] row_mask:0xf bank_mask:0xf
    v_dot2c_f32_bf16_dpp v19, v110, v14 quad_perm:[1,0,3,2] row_mask:0xf bank_mask:0xf
    v_dot2c_f32_bf16_dpp v16, v99, v15 quad_perm:[1,0,3,2] row_mask:0xf bank_mask:0xf
    v_dot2c_f32_bf16_dpp v17, v103, v15 quad_perm:[1,0,3,2] row_mask:0xf bank_mask:0xf
    v_dot2c_f32_bf16_dpp v18, v107, v15 quad_perm:[1,0,3,2] row_mask:0xf bank_mask:0xf
    v_dot2c_f32_bf16_dpp v19, v111, v15 quad_perm:[1,0,3,2] row_mask:0xf bank_mask:0xf
    v_dot2_f32_bf16 v20, v112, v8, 0
    v_dot2_f32_bf16 v21, v116, v8, 0
    v_dot2_f32_bf16 v22, v120, v8, 0
    v_dot2_f32_bf16 v23, v124, v8, 0
    v_dot2c_f32_bf16 v20, v113, v9
    v_dot2c_f32_bf16 v21, v117, v9
    v_dot2c_f32_bf16 v22, v121, v9
    v_dot2c_f32_bf16 v23, v125, v9
    v_dot2c_f32_bf16 v20, v114, v10
    v_dot2c_f32_bf16 v21, v118, v10
    v_dot2c_f32_bf16 v22, v122, v10
    v_dot2c_f32_bf16 v23, v126, v10
    v_dot2c_f32_bf16 v20, v115, v11
    v_dot2c_f32_bf16 v21, v119, v11
    v_dot2c_f32_bf16 v22, v123, v11
    v_dot2c_f32_bf16 v23, v127, v11
    v_dot2c_f32_bf16_dpp v20, v112, v12 quad_perm:[1,0,3,2] row_mask:0xf bank_mask:0xf
    v_dot2c_f32_bf16_dpp v21, v116, v12 quad_perm:[1,0,3,2] row_mask:0xf bank_mask:0xf
    v_dot2c_f32_bf16_dpp v22, v120, v12 quad_perm:[1,0,3,2] row_mask:0xf bank_mask:0xf
    v_dot2c_f32_bf16_dpp v23, v124, v12 quad_perm:[1,0,3,2] row_mask:0xf bank_mask:0xf
    v_dot2c_f32_bf16_dpp v20, v113, v13 quad_perm:[1,0,3,2] row_mask:0xf bank_mask:0xf
    v_dot2c_f32_bf16_dpp v21, v117, v13 quad_perm:[1,0,3,2] row_mask:0xf bank_mask:0xf
    v_dot2c_f32_bf16_dpp v22, v121, v13 quad_perm:[1,0,3,2] row_mask:0xf bank_mask:0xf
    v_dot2c_f32_bf16_dpp v23, v125, v13 quad_perm:[1,0,3,2] row_mask:0xf bank_mask:0xf
    v_dot2c_f32_bf16_dpp v20, v114, v14 quad_perm:[1,0,3,2] row_mask:0xf bank_mask:0xf
    v_dot2c_f32_bf16_dpp v21, v118, v14 quad_perm:[1,0,3,2] row_mask:0xf bank_mask:0xf
    v_dot2c_f32_bf16_dpp v22, v122, v14 quad_perm:[1,0,3,2] row_mask:0xf bank_mask:0xf
    v_dot2c_f32_bf16_dpp v23, v126, v14 quad_perm:[1,0,3,2] row_mask:0xf bank_mask:0xf
    v_dot2c_f32_bf16_dpp v20, v115, v15 quad_perm:[1,0,3,2] row_mask:0xf bank_mask:0xf
    v_dot2c_f32_bf16_dpp v21, v119, v15 quad_perm:[1,0,3,2] row_mask:0xf bank_mask:0xf
    v_dot2c_f32_bf16_dpp v22, v123, v15 quad_perm:[1,0,3,2] row_mask:0xf bank_mask:0xf
    v_dot2c_f32_bf16_dpp v23, v127, v15 quad_perm:[1,0,3,2] row_mask:0xf bank_mask:0xf
    v_add_f32_dpp v16, v16, v16 quad_perm:[2,3,0,1] row_mask:0xf bank_mask:0xf
    v_add_f32_dpp v17, v17, v17 quad_perm:[2,3,0,1] row_mask:0xf bank_mask:0xf
    v_add_f32_dpp v18, v18, v18 quad_perm:[2,3,0,1] row_mask:0xf bank_mask:0xf
    v_add_f32_dpp v19, v19, v19 quad_perm:[2,3,0,1] row_mask:0xf bank_mask:0xf
    v_add_f32_dpp v20, v20, v20 quad_perm:[2,3,0,1] row_mask:0xf bank_mask:0xf
    v_add_f32_dpp v21, v21, v21 quad_perm:[2,3,0,1] row_mask:0xf bank_mask:0xf
    v_add_f32_dpp v22, v22, v22 quad_perm:[2,3,0,1] row_mask:0xf bank_mask:0xf
    v_add_f32_dpp v23, v23, v23 quad_perm:[2,3,0,1] row_mask:0xf bank_mask:0xf
    v_add_f32_dpp v16, v16, v16 row_ror:4 row_mask:0xf bank_mask:0xf
    v_add_f32_dpp v17, v17, v17 row_ror:4 row_mask:0xf bank_mask:0xf
    v_add_f32_dpp v18, v18, v18 row_ror:4 row_mask:0xf bank_mask:0xf
    v_add_f32_dpp v19, v19, v19 row_ror:4 row_mask:0xf bank_mask:0xf
    v_add_f32_dpp v20, v20, v20 row_ror:4 row_mask:0xf bank_mask:0xf
    v_add_f32_dpp v21, v21, v21 row_ror:4 row_mask:0xf bank_mask:0xf
    v_add_f32_dpp v22, v22, v22 row_ror:4 row_mask:0xf bank_mask:0xf
    v_add_f32_dpp v23, v23, v23 row_ror:4 row_mask:0xf bank_mask:0xf
    v_add_f32_dpp v16, v16, v16 row_ror:8 row_mask:0xf bank_mask:0xf
    v_add_f32_dpp v17, v17, v17 row_ror:8 row_mask:0xf bank_mask:0xf
    v_add_f32_dpp v18, v18, v18 row_ror:8 row_mask:0xf bank_mask:0xf
    v_add_f32_dpp v19, v19, v19 row_ror:8 row_mask:0xf bank_mask:0xf
    v_add_f32_dpp v20, v20, v20 row_ror:8 row_mask:0xf bank_mask:0xf
    v_add_f32_dpp v21, v21, v21 row_ror:8 row_mask:0xf bank_mask:0xf
    v_add_f32_dpp v22, v22, v22 row_ror:8 row_mask:0xf bank_mask:0xf
    v_add_f32_dpp v23, v23, v23 row_ror:8 row_mask:0xf bank_mask:0xf
    v_mul_f32 v16, v16, v3
    v_mul_f32 v17, v17, v3
    v_mul_f32 v18, v18, v3
    v_mul_f32 v19, v19, v3
    v_mul_f32 v20, v20, v3
    v_mul_f32 v21, v21, v3
    v_mul_f32 v22, v22, v3
    v_mul_f32 v23, v23, v3
    v_max3_f32 v28, v16, v17, v18
    v_max3_f32 v28, v28, v19, v20
    v_max3_f32 v28, v28, v21, v22
    v_max3_f32 v28, v28, v23, v4
    v_mov_b32 v29, v28
    s_nop 1
    v_permlane16_swap_b32 v28, v29
    v_max_f32 v28, v28, v29
    v_mov_b32 v29, v28
    s_nop 1
    v_permlane32_swap_b32 v28, v29
    v_max_f32 v28, v28, v29
    v_sub_f32 v29, v4, v28
    v_sub_f32 v16, v16, v28
    v_sub_f32 v17, v17, v28
    v_sub_f32 v18, v18, v28
    v_sub_f32 v19, v19, v28
    v_sub_f32 v20, v20, v28
    v_sub_f32 v21, v21, v28
    v_sub_f32 v22, v22, v28
    v_sub_f32 v23, v23, v28
    v_exp_f32 v29, v29
    v_exp_f32 v16, v16
    v_exp_f32 v17, v17
    v_exp_f32 v18, v18
    v_exp_f32 v19, v19
    v_exp_f32 v20, v20
    v_exp_f32 v21, v21
    v_exp_f32 v22, v22
    v_exp_f32 v23, v23
    v_mov_b32 v4, v28
    v_cmp_neq_f32 vcc, 1.0, v29
    v_fma_f32 v5, v5, v29, v16
    v_add_f32 v30, v17, v18
    v_add_f32 v31, v19, v20
    v_add_f32 v5, v5, v21
    v_add_f32 v30, v30, v22
    v_add_f32 v31, v31, v23
    v_add_f32 v5, v5, v30
    v_add_f32 v5, v5, v31
    v_cvt_pk_bf16_f32 v24, v16, v17
    v_cvt_pk_bf16_f32 v25, v18, v19
    v_cvt_pk_bf16_f32 v26, v20, v21
    v_cvt_pk_bf16_f32 v27, v22, v23
    s_nop 0
    s_cbranch_vccz L_nors_60
    v_mul_f32 v32, v29, v32
    v_mul_f32 v33, v29, v33
    v_mul_f32 v34, v29, v34
    v_mul_f32 v35, v29, v35
    v_mul_f32 v36, v29, v36
    v_mul_f32 v37, v29, v37
    v_mul_f32 v38, v29, v38
    v_mul_f32 v39, v29, v39
    v_mul_f32 v40, v29, v40
    v_mul_f32 v41, v29, v41
    v_mul_f32 v42, v29, v42
    v_mul_f32 v43, v29, v43
    v_mul_f32 v44, v29, v44
    v_mul_f32 v45, v29, v45
    v_mul_f32 v46, v29, v46
    v_mul_f32 v47, v29, v47
    v_mul_f32 v48, v29, v48
    v_mul_f32 v49, v29, v49
    v_mul_f32 v50, v29, v50
    v_mul_f32 v51, v29, v51
    v_mul_f32 v52, v29, v52
    v_mul_f32 v53, v29, v53
    v_mul_f32 v54, v29, v54
    v_mul_f32 v55, v29, v55
    v_mul_f32 v56, v29, v56
    v_mul_f32 v57, v29, v57
    v_mul_f32 v58, v29, v58
    v_mul_f32 v59, v29, v59
    v_mul_f32 v60, v29, v60
    v_mul_f32 v61, v29, v61
    v_mul_f32 v62, v29, v62
    v_mul_f32 v63, v29, v63
L_nors_60:
    v_perm_b32 v64, v132, v128, s50
    v_perm_b32 v68, v132, v128, s51
    v_perm_b32 v72, v133, v129, s50
    v_perm_b32 v76, v133, v129, s51
    v_perm_b32 v80, v134, v130, s50
    v_perm_b32 v84, v134, v130, s51
    v_perm_b32 v88, v135, v131, s50
    v_perm_b32 v92, v135, v131, s51
    v_perm_b32 v65, v140, v136, s50
    v_perm_b32 v69, v140, v136, s51
    v_perm_b32 v73, v141, v137, s50
    v_perm_b32 v77, v141, v137, s51
    v_perm_b32 v81, v142, v138, s50
    v_perm_b32 v85, v142, v138, s51
    v_perm_b32 v89, v143, v139, s50
    v_perm_b32 v93, v143, v139, s51
    v_perm_b32 v66, v148, v144, s50
    v_perm_b32 v70, v148, v144, s51
    v_perm_b32 v74, v149, v145, s50
    v_perm_b32 v78, v149, v145, s51
    v_perm_b32 v82, v150, v146, s50
    v_perm_b32 v86, v150, v146, s51
    v_perm_b32 v90, v151, v147, s50
    v_perm_b32 v94, v151, v147, s51
    v_perm_b32 v67, v156, v152, s50
    v_perm_b32 v71, v156, v152, s51
    v_perm_b32 v75, v157, v153, s50
    v_perm_b32 v79, v157, v153, s51
    v_perm_b32 v83, v158, v154, s50
    v_perm_b32 v87, v158, v154, s51
    v_perm_b32 v91, v159, v155, s50
    v_perm_b32 v95, v159, v155, s51
    v_mfma_f32_16x16x32_bf16 v[32:35], v[64:67], v[24:27], v[32:35]
    v_mfma_f32_16x16x32_bf16 v[36:39], v[68:71], v[24:27], v[36:39]
    v_mfma_f32_16x16x32_bf16 v[40:43], v[72:75], v[24:27], v[40:43]
    v_mfma_f32_16x16x32_bf16 v[44:47], v[76:79], v[24:27], v[44:47]
    v_mfma_f32_16x16x32_bf16 v[48:51], v[80:83], v[24:27], v[48:51]
    v_mfma_f32_16x16x32_bf16 v[52:55], v[84:87], v[24:27], v[52:55]
    v_mfma_f32_16x16x32_bf16 v[56:59], v[88:91], v[24:27], v[56:59]
    v_mfma_f32_16x16x32_bf16 v[60:63], v[92:95], v[24:27], v[60:63]
    s_waitcnt vmcnt(8)
    v_dot2_f32_bf16 v16, v160, v8, 0
    v_dot2_f32_bf16 v17, v164, v8, 0
    v_dot2_f32_bf16 v18, v168, v8, 0
    v_dot2_f32_bf16 v19, v172, v8, 0
    v_dot2c_f32_bf16 v16, v161, v9
    v_dot2c_f32_bf16 v17, v165, v9
    v_dot2c_f32_bf16 v18, v169, v9
    v_dot2c_f32_bf16 v19, v173, v9
    v_dot2c_f32_bf16 v16, v162, v10
    v_dot2c_f32_bf16 v17, v166, v10
    v_dot2c_f32_bf16 v18, v170, v10
    v_dot2c_f32_bf16 v19, v174, v10
    v_dot2c_f32_bf16 v16, v163, v11
    v_dot2c_f32_bf16 v17, v167, v11
    v_dot2c_f32_bf16 v18, v171, v11
    v_dot2c_f32_bf16 v19, v175, v11
    v_dot2c_f32_bf16_dpp v16, v160, v12 quad_perm:[1,0,3,2] row_mask:0xf bank_mask:0xf
    v_dot2c_f32_bf16_dpp v17, v164, v12 quad_perm:[1,0,3,2] row_mask:0xf bank_mask:0xf
    v_dot2c_f32_bf16_dpp v18, v168, v12 quad_perm:[1,0,3,2] row_mask:0xf bank_mask:0xf
    v_dot2c_f32_bf16_dpp v19, v172, v12 quad_perm:[1,0,3,2] row_mask:0xf bank_mask:0xf
    v_dot2c_f32_bf16_dpp v16, v161, v13 quad_perm:[1,0,3,2] row_mask:0xf bank_mask:0xf
    v_dot2c_f32_bf16_dpp v17, v165, v13 quad_perm:[1,0,3,2] row_mask:0xf bank_mask:0xf
    v_dot2c_f32_bf16_dpp v18, v169, v13 quad_perm:[1,0,3,2] row_mask:0xf bank_mask:0xf
    v_dot2c_f32_bf16_dpp v19, v173, v13 quad_perm:[1,0,3,2] row_mask:0xf bank_mask:0xf
    v_dot2c_f32_bf16_dpp v16, v162, v14 quad_perm:[1,0,3,2] row_mask:0xf bank_mask:0xf
    v_dot2c_f32_bf16_dpp v17, v166, v14 quad_perm:[1,0,3,2] row_mask:0xf bank_mask:0xf
    v_dot2c_f32_bf16_dpp v18, v170, v14 quad_perm:[1,0,3,2] row_mask:0xf bank_mask:0xf
    v_dot2c_f32_bf16_dpp v19, v174, v14 quad_perm:[1,0,3,2] row_mask:0xf bank_mask:0xf
    v_dot2c_f32_bf16_dpp v16, v163, v15 quad_perm:[1,0,3,2] row_mask:0xf bank_mask:0xf
    v_dot2c_f32_bf16_dpp v17, v167, v15 quad_perm:[1,0,3,2] row_mask:0xf bank_mask:0xf
    v_dot2c_f32_bf16_dpp v18, v171, v15 quad_perm:[1,0,3,2] row_mask:0xf bank_mask:0xf
    v_dot2c_f32_bf16_dpp v19, v175, v15 quad_perm:[1,0,3,2] row_mask:0xf bank_mask:0xf
    v_dot2_f32_bf16 v20, v176, v8, 0
    v_dot2_f32_bf16 v21, v180, v8, 0
    v_dot2_f32_bf16 v22, v184, v8, 0
    v_dot2_f32_bf16 v23, v188, v8, 0
    v_dot2c_f32_bf16 v20, v177, v9
    v_dot2c_f32_bf16 v21, v181, v9
    v_dot2c_f32_bf16 v22, v185, v9
    v_dot2c_f32_bf16 v23, v189, v9
    v_dot2c_f32_bf16 v20, v178, v10
    v_dot2c_f32_bf16 v21, v182, v10
    v_dot2c_f32_bf16 v22, v186, v10
    v_dot2c_f32_bf16 v23, v190, v10
    v_dot2c_f32_bf16 v20, v179, v11
    v_dot2c_f32_bf16 v21, v183, v11
    v_dot2c_f32_bf16 v22, v187, v11
    v_dot2c_f32_bf16 v23, v191, v11
    v_dot2c_f32_bf16_dpp v20, v176, v12 quad_perm:[1,0,3,2] row_mask:0xf bank_mask:0xf
    v_dot2c_f32_bf16_dpp v21, v180, v12 quad_perm:[1,0,3,2] row_mask:0xf bank_mask:0xf
    v_dot2c_f32_bf16_dpp v22, v184, v12 quad_perm:[1,0,3,2] row_mask:0xf bank_mask:0xf
    v_dot2c_f32_bf16_dpp v23, v188, v12 quad_perm:[1,0,3,2] row_mask:0xf bank_mask:0xf
    v_dot2c_f32_bf16_dpp v20, v177, v13 quad_perm:[1,0,3,2] row_mask:0xf bank_mask:0xf
    v_dot2c_f32_bf16_dpp v21, v181, v13 quad_perm:[1,0,3,2] row_mask:0xf bank_mask:0xf
    v_dot2c_f32_bf16_dpp v22, v185, v13 quad_perm:[1,0,3,2] row_mask:0xf bank_mask:0xf
    v_dot2c_f32_bf16_dpp v23, v189, v13 quad_perm:[1,0,3,2] row_mask:0xf bank_mask:0xf
    v_dot2c_f32_bf16_dpp v20, v178, v14 quad_perm:[1,0,3,2] row_mask:0xf bank_mask:0xf
    v_dot2c_f32_bf16_dpp v21, v182, v14 quad_perm:[1,0,3,2] row_mask:0xf bank_mask:0xf
    v_dot2c_f32_bf16_dpp v22, v186, v14 quad_perm:[1,0,3,2] row_mask:0xf bank_mask:0xf
    v_dot2c_f32_bf16_dpp v23, v190, v14 quad_perm:[1,0,3,2] row_mask:0xf bank_mask:0xf
    v_dot2c_f32_bf16_dpp v20, v179, v15 quad_perm:[1,0,3,2] row_mask:0xf bank_mask:0xf
    v_dot2c_f32_bf16_dpp v21, v183, v15 quad_perm:[1,0,3,2] row_mask:0xf bank_mask:0xf
    v_dot2c_f32_bf16_dpp v22, v187, v15 quad_perm:[1,0,3,2] row_mask:0xf bank_mask:0xf
    v_dot2c_f32_bf16_dpp v23, v191, v15 quad_perm:[1,0,3,2] row_mask:0xf bank_mask:0xf
    v_add_f32_dpp v16, v16, v16 quad_perm:[2,3,0,1] row_mask:0xf bank_mask:0xf
    v_add_f32_dpp v17, v17, v17 quad_perm:[2,3,0,1] row_mask:0xf bank_mask:0xf
    v_add_f32_dpp v18, v18, v18 quad_perm:[2,3,0,1] row_mask:0xf bank_mask:0xf
    v_add_f32_dpp v19, v19, v19 quad_perm:[2,3,0,1] row_mask:0xf bank_mask:0xf
    v_add_f32_dpp v20, v20, v20 quad_perm:[2,3,0,1] row_mask:0xf bank_mask:0xf
    v_add_f32_dpp v21, v21, v21 quad_perm:[2,3,0,1] row_mask:0xf bank_mask:0xf
    v_add_f32_dpp v22, v22, v22 quad_perm:[2,3,0,1] row_mask:0xf bank_mask:0xf
    v_add_f32_dpp v23, v23, v23 quad_perm:[2,3,0,1] row_mask:0xf bank_mask:0xf
    v_add_f32_dpp v16, v16, v16 row_ror:4 row_mask:0xf bank_mask:0xf
    v_add_f32_dpp v17, v17, v17 row_ror:4 row_mask:0xf bank_mask:0xf
    v_add_f32_dpp v18, v18, v18 row_ror:4 row_mask:0xf bank_mask:0xf
    v_add_f32_dpp v19, v19, v19 row_ror:4 row_mask:0xf bank_mask:0xf
    v_add_f32_dpp v20, v20, v20 row_ror:4 row_mask:0xf bank_mask:0xf
    v_add_f32_dpp v21, v21, v21 row_ror:4 row_mask:0xf bank_mask:0xf
    v_add_f32_dpp v22, v22, v22 row_ror:4 row_mask:0xf bank_mask:0xf
    v_add_f32_dpp v23, v23, v23 row_ror:4 row_mask:0xf bank_mask:0xf
    v_add_f32_dpp v16, v16, v16 row_ror:8 row_mask:0xf bank_mask:0xf
    v_add_f32_dpp v17, v17, v17 row_ror:8 row_mask:0xf bank_mask:0xf
    v_add_f32_dpp v18, v18, v18 row_ror:8 row_mask:0xf bank_mask:0xf
    v_add_f32_dpp v19, v19, v19 row_ror:8 row_mask:0xf bank_mask:0xf
    v_add_f32_dpp v20, v20, v20 row_ror:8 row_mask:0xf bank_mask:0xf
    v_add_f32_dpp v21, v21, v21 row_ror:8 row_mask:0xf bank_mask:0xf
    v_add_f32_dpp v22, v22, v22 row_ror:8 row_mask:0xf bank_mask:0xf
    v_add_f32_dpp v23, v23, v23 row_ror:8 row_mask:0xf bank_mask:0xf
    v_mul_f32 v16, v16, v3
    v_mul_f32 v17, v17, v3
    v_mul_f32 v18, v18, v3
    v_mul_f32 v19, v19, v3
    v_mul_f32 v20, v20, v3
    v_mul_f32 v21, v21, v3
    v_mul_f32 v22, v22, v3
    v_mul_f32 v23, v23, v3
    v_max3_f32 v28, v16, v17, v18
    v_max3_f32 v28, v28, v19, v20
    v_max3_f32 v28, v28, v21, v22
    v_max3_f32 v28, v28, v23, v4
    v_mov_b32 v29, v28
    s_nop 1
    v_permlane16_swap_b32 v28, v29
    v_max_f32 v28, v28, v29
    v_mov_b32 v29, v28
    s_nop 1
    v_permlane32_swap_b32 v28, v29
    v_max_f32 v28, v28, v29
    v_sub_f32 v29, v4, v28
    v_sub_f32 v16, v16, v28
    v_sub_f32 v17, v17, v28
    v_sub_f32 v18, v18, v28
    v_sub_f32 v19, v19, v28
    v_sub_f32 v20, v20, v28
    v_sub_f32 v21, v21, v28
    v_sub_f32 v22, v22, v28
    v_sub_f32 v23, v23, v28
    v_exp_f32 v29, v29
    v_exp_f32 v16, v16
    v_exp_f32 v17, v17
    v_exp_f32 v18, v18
    v_exp_f32 v19, v19
    v_exp_f32 v20, v20
    v_exp_f32 v21, v21
    v_exp_f32 v22, v22
    v_exp_f32 v23, v23
    v_mov_b32 v4, v28
    v_cmp_neq_f32 vcc, 1.0, v29
    v_fma_f32 v5, v5, v29, v16
    v_add_f32 v30, v17, v18
    v_add_f32 v31, v19, v20
    v_add_f32 v5, v5, v21
    v_add_f32 v30, v30, v22
    v_add_f32 v31, v31, v23
    v_add_f32 v5, v5, v30
    v_add_f32 v5, v5, v31
    v_cvt_pk_bf16_f32 v24, v16, v17
    v_cvt_pk_bf16_f32 v25, v18, v19
    v_cvt_pk_bf16_f32 v26, v20, v21
    v_cvt_pk_bf16_f32 v27, v22, v23
    s_nop 0
    s_cbranch_vccz L_nors_61
    v_mul_f32 v32, v29, v32
    v_mul_f32 v33, v29, v33
    v_mul_f32 v34, v29, v34
    v_mul_f32 v35, v29, v35
    v_mul_f32 v36, v29, v36
    v_mul_f32 v37, v29, v37
    v_mul_f32 v38, v29, v38
    v_mul_f32 v39, v29, v39
    v_mul_f32 v40, v29, v40
    v_mul_f32 v41, v29, v41
    v_mul_f32 v42, v29, v42
    v_mul_f32 v43, v29, v43
    v_mul_f32 v44, v29, v44
    v_mul_f32 v45, v29, v45
    v_mul_f32 v46, v29, v46
    v_mul_f32 v47, v29, v47
    v_mul_f32 v48, v29, v48
    v_mul_f32 v49, v29, v49
    v_mul_f32 v50, v29, v50
    v_mul_f32 v51, v29, v51
    v_mul_f32 v52, v29, v52
    v_mul_f32 v53, v29, v53
    v_mul_f32 v54, v29, v54
    v_mul_f32 v55, v29, v55
    v_mul_f32 v56, v29, v56
    v_mul_f32 v57, v29, v57
    v_mul_f32 v58, v29, v58
    v_mul_f32 v59, v29, v59
    v_mul_f32 v60, v29, v60
    v_mul_f32 v61, v29, v61
    v_mul_f32 v62, v29, v62
    v_mul_f32 v63, v29, v63
L_nors_61:
    v_mov_b32 v29, v5
    s_nop 1
    v_permlane16_swap_b32 v5, v29
    v_add_f32 v5, v5, v29
    v_mov_b32 v29, v5
    s_nop 1
    v_permlane32_swap_b32 v5, v29
    v_add_f32 v5, v5, v29
    s_waitcnt vmcnt(6)
    v_perm_b32 v64, v196, v192, s50
    v_perm_b32 v68, v196, v192, s51
    v_perm_b32 v72, v197, v193, s50
    v_perm_b32 v76, v197, v193, s51
    v_perm_b32 v80, v198, v194, s50
    v_perm_b32 v84, v198, v194, s51
    v_perm_b32 v88, v199, v195, s50
    v_perm_b32 v92, v199, v195, s51
    s_waitcnt vmcnt(4)
    v_perm_b32 v65, v204, v200, s50
    v_perm_b32 v69, v204, v200, s51
    v_perm_b32 v73, v205, v201, s50
    v_perm_b32 v77, v205, v201, s51
    v_perm_b32 v81, v206, v202, s50
    v_perm_b32 v85, v206, v202, s51
    v_perm_b32 v89, v207, v203, s50
    v_perm_b32 v93, v207, v203, s51
    s_waitcnt vmcnt(2)
    v_perm_b32 v66, v212, v208, s50
    v_perm_b32 v70, v212, v208, s51
    v_perm_b32 v74, v213, v209, s50
    v_perm_b32 v78, v213, v209, s51
    v_perm_b32 v82, v214, v210, s50
    v_perm_b32 v86, v214, v210, s51
    v_perm_b32 v90, v215, v211, s50
    v_perm_b32 v94, v215, v211, s51
    s_waitcnt vmcnt(0)
    v_perm_b32 v67, v220, v216, s50
    v_perm_b32 v71, v220, v216, s51
    v_perm_b32 v75, v221, v217, s50
    v_perm_b32 v79, v221, v217, s51
    v_perm_b32 v83, v222, v218, s50
    v_perm_b32 v87, v222, v218, s51
    v_perm_b32 v91, v223, v219, s50
    v_perm_b32 v95, v223, v219, s51
    v_mfma_f32_16x16x32_bf16 v[32:35], v[64:67], v[24:27], v[32:35]
    v_mfma_f32_16x16x32_bf16 v[36:39], v[68:71], v[24:27], v[36:39]
    v_mfma_f32_16x16x32_bf16 v[40:43], v[72:75], v[24:27], v[40:43]
    v_mfma_f32_16x16x32_bf16 v[44:47], v[76:79], v[24:27], v[44:47]
    v_mfma_f32_16x16x32_bf16 v[48:51], v[80:83], v[24:27], v[48:51]
    v_mfma_f32_16x16x32_bf16 v[52:55], v[84:87], v[24:27], v[52:55]
    v_mfma_f32_16x16x32_bf16 v[56:59], v[88:91], v[24:27], v[56:59]
    v_mfma_f32_16x16x32_bf16 v[60:63], v[92:95], v[24:27], v[60:63]
    s_nop 6
    s_branch L_adone_57
L_aeB_56:
    v_dot2_f32_bf16 v16, v160, v8, 0
    v_dot2_f32_bf16 v17, v164, v8, 0
    v_dot2_f32_bf16 v18, v168, v8, 0
    v_dot2_f32_bf16 v19, v172, v8, 0
    v_dot2c_f32_bf16 v16, v161, v9
    v_dot2c_f32_bf16 v17, v165, v9
    v_dot2c_f32_bf16 v18, v169, v9
    v_dot2c_f32_bf16 v19, v173, v9
    v_dot2c_f32_bf16 v16, v162, v10
    v_dot2c_f32_bf16 v17, v166, v10
    v_dot2c_f32_bf16 v18, v170, v10
    v_dot2c_f32_bf16 v19, v174, v10
    v_dot2c_f32_bf16 v16, v163, v11
    v_dot2c_f32_bf16 v17, v167, v11
    v_dot2c_f32_bf16 v18, v171, v11
    v_dot2c_f32_bf16 v19, v175, v11
    v_dot2c_f32_bf16_dpp v16, v160, v12 quad_perm:[1,0,3,2] row_mask:0xf bank_mask:0xf
    v_dot2c_f32_bf16_dpp v17, v164, v12 quad_perm:[1,0,3,2] row_mask:0xf bank_mask:0xf
    v_dot2c_f32_bf16_dpp v18, v168, v12 quad_perm:[1,0,3,2] row_mask:0xf bank_mask:0xf
    v_dot2c_f32_bf16_dpp v19, v172, v12 quad_perm:[1,0,3,2] row_mask:0xf bank_mask:0xf
    v_dot2c_f32_bf16_dpp v16, v161, v13 quad_perm:[1,0,3,2] row_mask:0xf bank_mask:0xf
    v_dot2c_f32_bf16_dpp v17, v165, v13 quad_perm:[1,0,3,2] row_mask:0xf bank_mask:0xf
    v_dot2c_f32_bf16_dpp v18, v169, v13 quad_perm:[1,0,3,2] row_mask:0xf bank_mask:0xf
    v_dot2c_f32_bf16_dpp v19, v173, v13 quad_perm:[1,0,3,2] row_mask:0xf bank_mask:0xf
    v_dot2c_f32_bf16_dpp v16, v162, v14 quad_perm:[1,0,3,2] row_mask:0xf bank_mask:0xf
    v_dot2c_f32_bf16_dpp v17, v166, v14 quad_perm:[1,0,3,2] row_mask:0xf bank_mask:0xf
    v_dot2c_f32_bf16_dpp v18, v170, v14 quad_perm:[1,0,3,2] row_mask:0xf bank_mask:0xf
    v_dot2c_f32_bf16_dpp v19, v174, v14 quad_perm:[1,0,3,2] row_mask:0xf bank_mask:0xf
    v_dot2c_f32_bf16_dpp v16, v163, v15 quad_perm:[1,0,3,2] row_mask:0xf bank_mask:0xf
    v_dot2c_f32_bf16_dpp v17, v167, v15 quad_perm:[1,0,3,2] row_mask:0xf bank_mask:0xf
    v_dot2c_f32_bf16_dpp v18, v171, v15 quad_perm:[1,0,3,2] row_mask:0xf bank_mask:0xf
    v_dot2c_f32_bf16_dpp v19, v175, v15 quad_perm:[1,0,3,2] row_mask:0xf bank_mask:0xf
    v_dot2_f32_bf16 v20, v176, v8, 0
    v_dot2_f32_bf16 v21, v180, v8, 0
    v_dot2_f32_bf16 v22, v184, v8, 0
    v_dot2_f32_bf16 v23, v188, v8, 0
    v_dot2c_f32_bf16 v20, v177, v9
    v_dot2c_f32_bf16 v21, v181, v9
    v_dot2c_f32_bf16 v22, v185, v9
    v_dot2c_f32_bf16 v23, v189, v9
    v_dot2c_f32_bf16 v20, v178, v10
    v_dot2c_f32_bf16 v21, v182, v10
    v_dot2c_f32_bf16 v22, v186, v10
    v_dot2c_f32_bf16 v23, v190, v10
    v_dot2c_f32_bf16 v20, v179, v11
    v_dot2c_f32_bf16 v21, v183, v11
    v_dot2c_f32_bf16 v22, v187, v11
    v_dot2c_f32_bf16 v23, v191, v11
    v_dot2c_f32_bf16_dpp v20, v176, v12 quad_perm:[1,0,3,2] row_mask:0xf bank_mask:0xf
    v_dot2c_f32_bf16_dpp v21, v180, v12 quad_perm:[1,0,3,2] row_mask:0xf bank_mask:0xf
    v_dot2c_f32_bf16_dpp v22, v184, v12 quad_perm:[1,0,3,2] row_mask:0xf bank_mask:0xf
    v_dot2c_f32_bf16_dpp v23, v188, v12 quad_perm:[1,0,3,2] row_mask:0xf bank_mask:0xf
    v_dot2c_f32_bf16_dpp v20, v177, v13 quad_perm:[1,0,3,2] row_mask:0xf bank_mask:0xf
    v_dot2c_f32_bf16_dpp v21, v181, v13 quad_perm:[1,0,3,2] row_mask:0xf bank_mask:0xf
    v_dot2c_f32_bf16_dpp v22, v185, v13 quad_perm:[1,0,3,2] row_mask:0xf bank_mask:0xf
    v_dot2c_f32_bf16_dpp v23, v189, v13 quad_perm:[1,0,3,2] row_mask:0xf bank_mask:0xf
    v_dot2c_f32_bf16_dpp v20, v178, v14 quad_perm:[1,0,3,2] row_mask:0xf bank_mask:0xf
    v_dot2c_f32_bf16_dpp v21, v182, v14 quad_perm:[1,0,3,2] row_mask:0xf bank_mask:0xf
    v_dot2c_f32_bf16_dpp v22, v186, v14 quad_perm:[1,0,3,2] row_mask:0xf bank_mask:0xf
    v_dot2c_f32_bf16_dpp v23, v190, v14 quad_perm:[1,0,3,2] row_mask:0xf bank_mask:0xf
    v_dot2c_f32_bf16_dpp v20, v179, v15 quad_perm:[1,0,3,2] row_mask:0xf bank_mask:0xf
    v_dot2c_f32_bf16_dpp v21, v183, v15 quad_perm:[1,0,3,2] row_mask:0xf bank_mask:0xf
    v_dot2c_f32_bf16_dpp v22, v187, v15 quad_perm:[1,0,3,2] row_mask:0xf bank_mask:0xf
    v_dot2c_f32_bf16_dpp v23, v191, v15 quad_perm:[1,0,3,2] row_mask:0xf bank_mask:0xf
    v_add_f32_dpp v16, v16, v16 quad_perm:[2,3,0,1] row_mask:0xf bank_mask:0xf
    v_add_f32_dpp v17, v17, v17 quad_perm:[2,3,0,1] row_mask:0xf bank_mask:0xf
    v_add_f32_dpp v18, v18, v18 quad_perm:[2,3,0,1] row_mask:0xf bank_mask:0xf
    v_add_f32_dpp v19, v19, v19 quad_perm:[2,3,0,1] row_mask:0xf bank_mask:0xf
    v_add_f32_dpp v20, v20, v20 quad_perm:[2,3,0,1] row_mask:0xf bank_mask:0xf
    v_add_f32_dpp v21, v21, v21 quad_perm:[2,3,0,1] row_mask:0xf bank_mask:0xf
    v_add_f32_dpp v22, v22, v22 quad_perm:[2,3,0,1] row_mask:0xf bank_mask:0xf
    v_add_f32_dpp v23, v23, v23 quad_perm:[2,3,0,1] row_mask:0xf bank_mask:0xf
    v_add_f32_dpp v16, v16, v16 row_ror:4 row_mask:0xf bank_mask:0xf
    v_add_f32_dpp v17, v17, v17 row_ror:4 row_mask:0xf bank_mask:0xf
    v_add_f32_dpp v18, v18, v18 row_ror:4 row_mask:0xf bank_mask:0xf
    v_add_f32_dpp v19, v19, v19 row_ror:4 row_mask:0xf bank_mask:0xf
    v_add_f32_dpp v20, v20, v20 row_ror:4 row_mask:0xf bank_mask:0xf
    v_add_f32_dpp v21, v21, v21 row_ror:4 row_mask:0xf bank_mask:0xf
    v_add_f32_dpp v22, v22, v22 row_ror:4 row_mask:0xf bank_mask:0xf
    v_add_f32_dpp v23, v23, v23 row_ror:4 row_mask:0xf bank_mask:0xf
    v_add_f32_dpp v16, v16, v16 row_ror:8 row_mask:0xf bank_mask:0xf
    v_add_f32_dpp v17, v17, v17 row_ror:8 row_mask:0xf bank_mask:0xf
    v_add_f32_dpp v18, v18, v18 row_ror:8 row_mask:0xf bank_mask:0xf
    v_add_f32_dpp v19, v19, v19 row_ror:8 row_mask:0xf bank_mask:0xf
    v_add_f32_dpp v20, v20, v20 row_ror:8 row_mask:0xf bank_mask:0xf
    v_add_f32_dpp v21, v21, v21 row_ror:8 row_mask:0xf bank_mask:0xf
    v_add_f32_dpp v22, v22, v22 row_ror:8 row_mask:0xf bank_mask:0xf
    v_add_f32_dpp v23, v23, v23 row_ror:8 row_mask:0xf bank_mask:0xf
    v_mul_f32 v16, v16, v3
    v_mul_f32 v17, v17, v3
    v_mul_f32 v18, v18, v3
    v_mul_f32 v19, v19, v3
    v_mul_f32 v20, v20, v3
    v_mul_f32 v21, v21, v3
    v_mul_f32 v22, v22, v3
    v_mul_f32 v23, v23, v3
    v_max3_f32 v28, v16, v17, v18
    v_max3_f32 v28, v28, v19, v20
    v_max3_f32 v28, v28, v21, v22
    v_max3_f32 v28, v28, v23, v4
    v_mov_b32 v29, v28
    s_nop 1
    v_permlane16_swap_b32 v28, v29
    v_max_f32 v28, v28, v29
    v_mov_b32 v29, v28
    s_nop 1
    v_permlane32_swap_b32 v28, v29
    v_max_f32 v28, v28, v29
    v_sub_f32 v29, v4, v28
    v_sub_f32 v16, v16, v28
    v_sub_f32 v17, v17, v28
    v_sub_f32 v18, v18, v28
    v_sub_f32 v19, v19, v28
    v_sub_f32 v20, v20, v28
    v_sub_f32 v21, v21, v28
    v_sub_f32 v22, v22, v28
    v_sub_f32 v23, v23, v28
    v_exp_f32 v29, v29
    v_exp_f32 v16, v16
    v_exp_f32 v17, v17
    v_exp_f32 v18, v18
    v_exp_f32 v19, v19
    v_exp_f32 v20, v20
    v_exp_f32 v21, v21
    v_exp_f32 v22, v22
    v_exp_f32 v23, v23
    v_mov_b32 v4, v28
    v_cmp_neq_f32 vcc, 1.0, v29
    v_fma_f32 v5, v5, v29, v16
    v_add_f32 v30, v17, v18
    v_add_f32 v31, v19, v20
    v_add_f32 v5, v5, v21
    v_add_f32 v30, v30, v22
    v_add_f32 v31, v31, v23
    v_add_f32 v5, v5, v30
    v_add_f32 v5, v5, v31
    v_cvt_pk_bf16_f32 v24, v16, v17
    v_cvt_pk_bf16_f32 v25, v18, v19
    v_cvt_pk_bf16_f32 v26, v20, v21
    v_cvt_pk_bf16_f32 v27, v22, v23
    s_nop 0
    s_cbranch_vccz L_nors_62
    v_mul_f32 v32, v29, v32
    v_mul_f32 v33, v29, v33
    v_mul_f32 v34, v29, v34
    v_mul_f32 v35, v29, v35
    v_mul_f32 v36, v29, v36
    v_mul_f32 v37, v29, v37
    v_mul_f32 v38, v29, v38
    v_mul_f32 v39, v29, v39
    v_mul_f32 v40, v29, v40
    v_mul_f32 v41, v29, v41
    v_mul_f32 v42, v29, v42
    v_mul_f32 v43, v29, v43
    v_mul_f32 v44, v29, v44
    v_mul_f32 v45, v29, v45
    v_mul_f32 v46, v29, v46
    v_mul_f32 v47, v29, v47
    v_mul_f32 v48, v29, v48
    v_mul_f32 v49, v29, v49
    v_mul_f32 v50, v29, v50
    v_mul_f32 v51, v29, v51
    v_mul_f32 v52, v29, v52
    v_mul_f32 v53, v29, v53
    v_mul_f32 v54, v29, v54
    v_mul_f32 v55, v29, v55
    v_mul_f32 v56, v29, v56
    v_mul_f32 v57, v29, v57
    v_mul_f32 v58, v29, v58
    v_mul_f32 v59, v29, v59
    v_mul_f32 v60, v29, v60
    v_mul_f32 v61, v29, v61
    v_mul_f32 v62, v29, v62
    v_mul_f32 v63, v29, v63
L_nors_62:
    v_perm_b32 v64, v196, v192, s50
    v_perm_b32 v68, v196, v192, s51
    v_perm_b32 v72, v197, v193, s50
    v_perm_b32 v76, v197, v193, s51
    v_perm_b32 v80, v198, v194, s50
    v_perm_b32 v84, v198, v194, s51
    v_perm_b32 v88, v199, v195, s50
    v_perm_b32 v92, v199, v195, s51
    v_perm_b32 v65, v204, v200, s50
    v_perm_b32 v69, v204, v200, s51
    v_perm_b32 v73, v205, v201, s50
    v_perm_b32 v77, v205, v201, s51
    v_perm_b32 v81, v206, v202, s50
    v_perm_b32 v85, v206, v202, s51
    v_perm_b32 v89, v207, v203, s50
    v_perm_b32 v93, v207, v203, s51
    v_perm_b32 v66, v212, v208, s50
    v_perm_b32 v70, v212, v208, s51
    v_perm_b32 v74, v213, v209, s50
    v_perm_b32 v78, v213, v209, s51
    v_perm_b32 v82, v214, v210, s50
    v_perm_b32 v86, v214, v210, s51
    v_perm_b32 v90, v215, v211, s50
    v_perm_b32 v94, v215, v211, s51
    v_perm_b32 v67, v220, v216, s50
    v_perm_b32 v71, v220, v216, s51
    v_perm_b32 v75, v221, v217, s50
    v_perm_b32 v79, v221, v217, s51
    v_perm_b32 v83, v222, v218, s50
    v_perm_b32 v87, v222, v218, s51
    v_perm_b32 v91, v223, v219, s50
    v_perm_b32 v95, v223, v219, s51
    v_mfma_f32_16x16x32_bf16 v[32:35], v[64:67], v[24:27], v[32:35]
    v_mfma_f32_16x16x32_bf16 v[36:39], v[68:71], v[24:27], v[36:39]
    v_mfma_f32_16x16x32_bf16 v[40:43], v[72:75], v[24:27], v[40:43]
    v_mfma_f32_16x16x32_bf16 v[44:47], v[76:79], v[24:27], v[44:47]
    v_mfma_f32_16x16x32_bf16 v[48:51], v[80:83], v[24:27], v[48:51]
    v_mfma_f32_16x16x32_bf16 v[52:55], v[84:87], v[24:27], v[52:55]
    v_mfma_f32_16x16x32_bf16 v[56:59], v[88:91], v[24:27], v[56:59]
    v_mfma_f32_16x16x32_bf16 v[60:63], v[92:95], v[24:27], v[60:63]
    s_waitcnt vmcnt(8)
    v_dot2_f32_bf16 v16, v96, v8, 0
    v_dot2_f32_bf16 v17, v100, v8, 0
    v_dot2_f32_bf16 v18, v104, v8, 0
    v_dot2_f32_bf16 v19, v108, v8, 0
    v_dot2c_f32_bf16 v16, v97, v9
    v_dot2c_f32_bf16 v17, v101, v9
    v_dot2c_f32_bf16 v18, v105, v9
    v_dot2c_f32_bf16 v19, v109, v9
    v_dot2c_f32_bf16 v16, v98, v10
    v_dot2c_f32_bf16 v17, v102, v10
    v_dot2c_f32_bf16 v18, v106, v10
    v_dot2c_f32_bf16 v19, v110, v10
    v_dot2c_f32_bf16 v16, v99, v11
    v_dot2c_f32_bf16 v17, v103, v11
    v_dot2c_f32_bf16 v18, v107, v11
    v_dot2c_f32_bf16 v19, v111, v11
    v_dot2c_f32_bf16_dpp v16, v96, v12 quad_perm:[1,0,3,2] row_mask:0xf bank_mask:0xf
    v_dot2c_f32_bf16_dpp v17, v100, v12 quad_perm:[1,0,3,2] row_mask:0xf bank_mask:0xf
    v_dot2c_f32_bf16_dpp v18, v104, v12 quad_perm:[1,0,3,2] row_mask:0xf bank_mask:0xf
    v_dot2c_f32_bf16_dpp v19, v108, v12 quad_perm:[1,0,3,2] row_mask:0xf bank_mask:0xf
    v_dot2c_f32_bf16_dpp v16, v97, v13 quad_perm:[1,0,3,2] row_mask:0xf bank_mask:0xf
    v_dot2c_f32_bf16_dpp v17, v101, v13 quad_perm:[1,0,3,2] row_mask:0xf bank_mask:0xf
    v_dot2c_f32_bf16_dpp v18, v105, v13 quad_perm:[1,0,3,2] row_mask:0xf bank_mask:0xf
    v_dot2c_f32_bf16_dpp v19, v109, v13 quad_perm:[1,0,3,2] row_mask:0xf bank_mask:0xf
    v_dot2c_f32_bf16_dpp v16, v98, v14 quad_perm:[1,0,3,2] row_mask:0xf bank_mask:0xf
    v_dot2c_f32_bf16_dpp v17, v102, v14 quad_perm:[1,0,3,2] row_mask:0xf bank_mask:0xf
    v_dot2c_f32_bf16_dpp v18, v106, v14 quad_perm:[1,0,3,2] row_mask:0xf bank_mask:0xf
    v_dot2c_f32_bf16_dpp v19, v110, v14 quad_perm:[1,0,3,2] row_mask:0xf bank_mask:0xf
    v_dot2c_f32_bf16_dpp v16, v99, v15 quad_perm:[1,0,3,2] row_mask:0xf bank_mask:0xf
    v_dot2c_f32_bf16_dpp v17, v103, v15 quad_perm:[1,0,3,2] row_mask:0xf bank_mask:0xf
    v_dot2c_f32_bf16_dpp v18, v107, v15 quad_perm:[1,0,3,2] row_mask:0xf bank_mask:0xf
    v_dot2c_f32_bf16_dpp v19, v111, v15 quad_perm:[1,0,3,2] row_mask:0xf bank_mask:0xf
    v_dot2_f32_bf16 v20, v112, v8, 0
    v_dot2_f32_bf16 v21, v116, v8, 0
    v_dot2_f32_bf16 v22, v120, v8, 0
    v_dot2_f32_bf16 v23, v124, v8, 0
    v_dot2c_f32_bf16 v20, v113, v9
    v_dot2c_f32_bf16 v21, v117, v9
    v_dot2c_f32_bf16 v22, v121, v9
    v_dot2c_f32_bf16 v23, v125, v9
    v_dot2c_f32_bf16 v20, v114, v10
    v_dot2c_f32_bf16 v21, v118, v10
    v_dot2c_f32_bf16 v22, v122, v10
    v_dot2c_f32_bf16 v23, v126, v10
    v_dot2c_f32_bf16 v20, v115, v11
    v_dot2c_f32_bf16 v21, v119, v11
    v_dot2c_f32_bf16 v22, v123, v11
    v_dot2c_f32_bf16 v23, v127, v11
    v_dot2c_f32_bf16_dpp v20, v112, v12 quad_perm:[1,0,3,2] row_mask:0xf bank_mask:0xf
    v_dot2c_f32_bf16_dpp v21, v116, v12 quad_perm:[1,0,3,2] row_mask:0xf bank_mask:0xf
    v_dot2c_f32_bf16_dpp v22, v120, v12 quad_perm:[1,0,3,2] row_mask:0xf bank_mask:0xf
    v_dot2c_f32_bf16_dpp v23, v124, v12 quad_perm:[1,0,3,2] row_mask:0xf bank_mask:0xf
    v_dot2c_f32_bf16_dpp v20, v113, v13 quad_perm:[1,0,3,2] row_mask:0xf bank_mask:0xf
    v_dot2c_f32_bf16_dpp v21, v117, v13 quad_perm:[1,0,3,2] row_mask:0xf bank_mask:0xf
    v_dot2c_f32_bf16_dpp v22, v121, v13 quad_perm:[1,0,3,2] row_mask:0xf bank_mask:0xf
    v_dot2c_f32_bf16_dpp v23, v125, v13 quad_perm:[1,0,3,2] row_mask:0xf bank_mask:0xf
    v_dot2c_f32_bf16_dpp v20, v114, v14 quad_perm:[1,0,3,2] row_mask:0xf bank_mask:0xf
    v_dot2c_f32_bf16_dpp v21, v118, v14 quad_perm:[1,0,3,2] row_mask:0xf bank_mask:0xf
    v_dot2c_f32_bf16_dpp v22, v122, v14 quad_perm:[1,0,3,2] row_mask:0xf bank_mask:0xf
    v_dot2c_f32_bf16_dpp v23, v126, v14 quad_perm:[1,0,3,2] row_mask:0xf bank_mask:0xf
    v_dot2c_f32_bf16_dpp v20, v115, v15 quad_perm:[1,0,3,2] row_mask:0xf bank_mask:0xf
    v_dot2c_f32_bf16_dpp v21, v119, v15 quad_perm:[1,0,3,2] row_mask:0xf bank_mask:0xf
    v_dot2c_f32_bf16_dpp v22, v123, v15 quad_perm:[1,0,3,2] row_mask:0xf bank_mask:0xf
    v_dot2c_f32_bf16_dpp v23, v127, v15 quad_perm:[1,0,3,2] row_mask:0xf bank_mask:0xf
    v_add_f32_dpp v16, v16, v16 quad_perm:[2,3,0,1] row_mask:0xf bank_mask:0xf
    v_add_f32_dpp v17, v17, v17 quad_perm:[2,3,0,1] row_mask:0xf bank_mask:0xf
    v_add_f32_dpp v18, v18, v18 quad_perm:[2,3,0,1] row_mask:0xf bank_mask:0xf
    v_add_f32_dpp v19, v19, v19 quad_perm:[2,3,0,1] row_mask:0xf bank_mask:0xf
    v_add_f32_dpp v20, v20, v20 quad_perm:[2,3,0,1] row_mask:0xf bank_mask:0xf
    v_add_f32_dpp v21, v21, v21 quad_perm:[2,3,0,1] row_mask:0xf bank_mask:0xf
    v_add_f32_dpp v22, v22, v22 quad_perm:[2,3,0,1] row_mask:0xf bank_mask:0xf
    v_add_f32_dpp v23, v23, v23 quad_perm:[2,3,0,1] row_mask:0xf bank_mask:0xf
    v_add_f32_dpp v16, v16, v16 row_ror:4 row_mask:0xf bank_mask:0xf
    v_add_f32_dpp v17, v17, v17 row_ror:4 row_mask:0xf bank_mask:0xf
    v_add_f32_dpp v18, v18, v18 row_ror:4 row_mask:0xf bank_mask:0xf
    v_add_f32_dpp v19, v19, v19 row_ror:4 row_mask:0xf bank_mask:0xf
    v_add_f32_dpp v20, v20, v20 row_ror:4 row_mask:0xf bank_mask:0xf
    v_add_f32_dpp v21, v21, v21 row_ror:4 row_mask:0xf bank_mask:0xf
    v_add_f32_dpp v22, v22, v22 row_ror:4 row_mask:0xf bank_mask:0xf
    v_add_f32_dpp v23, v23, v23 row_ror:4 row_mask:0xf bank_mask:0xf
    v_add_f32_dpp v16, v16, v16 row_ror:8 row_mask:0xf bank_mask:0xf
    v_add_f32_dpp v17, v17, v17 row_ror:8 row_mask:0xf bank_mask:0xf
    v_add_f32_dpp v18, v18, v18 row_ror:8 row_mask:0xf bank_mask:0xf
    v_add_f32_dpp v19, v19, v19 row_ror:8 row_mask:0xf bank_mask:0xf
    v_add_f32_dpp v20, v20, v20 row_ror:8 row_mask:0xf bank_mask:0xf
    v_add_f32_dpp v21, v21, v21 row_ror:8 row_mask:0xf bank_mask:0xf
    v_add_f32_dpp v22, v22, v22 row_ror:8 row_mask:0xf bank_mask:0xf
    v_add_f32_dpp v23, v23, v23 row_ror:8 row_mask:0xf bank_mask:0xf
    v_mul_f32 v16, v16, v3
    v_mul_f32 v17, v17, v3
    v_mul_f32 v18, v18, v3
    v_mul_f32 v19, v19, v3
    v_mul_f32 v20, v20, v3
    v_mul_f32 v21, v21, v3
    v_mul_f32 v22, v22, v3
    v_mul_f32 v23, v23, v3
    v_max3_f32 v28, v16, v17, v18
    v_max3_f32 v28, v28, v19, v20
    v_max3_f32 v28, v28, v21, v22
    v_max3_f32 v28, v28, v23, v4
    v_mov_b32 v29, v28
    s_nop 1
    v_permlane16_swap_b32 v28, v29
    v_max_f32 v28, v28, v29
    v_mov_b32 v29, v28
    s_nop 1
    v_permlane32_swap_b32 v28, v29
    v_max_f32 v28, v28, v29
    v_sub_f32 v29, v4, v28
    v_sub_f32 v16, v16, v28
    v_sub_f32 v17, v17, v28
    v_sub_f32 v18, v18, v28
    v_sub_f32 v19, v19, v28
    v_sub_f32 v20, v20, v28
    v_sub_f32 v21, v21, v28
    v_sub_f32 v22, v22, v28
    v_sub_f32 v23, v23, v28
    v_exp_f32 v29, v29
    v_exp_f32 v16, v16
    v_exp_f32 v17, v17
    v_exp_f32 v18, v18
    v_exp_f32 v19, v19
    v_exp_f32 v20, v20
    v_exp_f32 v21, v21
    v_exp_f32 v22, v22
    v_exp_f32 v23, v23
    v_mov_b32 v4, v28
    v_cmp_neq_f32 vcc, 1.0, v29
    v_fma_f32 v5, v5, v29, v16
    v_add_f32 v30, v17, v18
    v_add_f32 v31, v19, v20
    v_add_f32 v5, v5, v21
    v_add_f32 v30, v30, v22
    v_add_f32 v31, v31, v23
    v_add_f32 v5, v5, v30
    v_add_f32 v5, v5, v31
    v_cvt_pk_bf16_f32 v24, v16, v17
    v_cvt_pk_bf16_f32 v25, v18, v19
    v_cvt_pk_bf16_f32 v26, v20, v21
    v_cvt_pk_bf16_f32 v27, v22, v23
    s_nop 0
    s_cbranch_vccz L_nors_63
    v_mul_f32 v32, v29, v32
    v_mul_f32 v33, v29, v33
    v_mul_f32 v34, v29, v34
    v_mul_f32 v35, v29, v35
    v_mul_f32 v36, v29, v36
    v_mul_f32 v37, v29, v37
    v_mul_f32 v38, v29, v38
    v_mul_f32 v39, v29, v39
    v_mul_f32 v40, v29, v40
    v_mul_f32 v41, v29, v41
    v_mul_f32 v42, v29, v42
    v_mul_f32 v43, v29, v43
    v_mul_f32 v44, v29, v44
    v_mul_f32 v45, v29, v45
    v_mul_f32 v46, v29, v46
    v_mul_f32 v47, v29, v47
    v_mul_f32 v48, v29, v48
    v_mul_f32 v49, v29, v49
    v_mul_f32 v50, v29, v50
    v_mul_f32 v51, v29, v51
    v_mul_f32 v52, v29, v52
    v_mul_f32 v53, v29, v53
    v_mul_f32 v54, v29, v54
    v_mul_f32 v55, v29, v55
    v_mul_f32 v56, v29, v56
    v_mul_f32 v57, v29, v57
    v_mul_f32 v58, v29, v58
    v_mul_f32 v59, v29, v59
    v_mul_f32 v60, v29, v60
    v_mul_f32 v61, v29, v61
    v_mul_f32 v62, v29, v62
    v_mul_f32 v63, v29, v63
L_nors_63:
    v_mov_b32 v29, v5
    s_nop 1
    v_permlane16_swap_b32 v5, v29
    v_add_f32 v5, v5, v29
    v_mov_b32 v29, v5
    s_nop 1
    v_permlane32_swap_b32 v5, v29
    v_add_f32 v5, v5, v29
    s_waitcnt vmcnt(6)
    v_perm_b32 v64, v132, v128, s50
    v_perm_b32 v68, v132, v128, s51
    v_perm_b32 v72, v133, v129, s50
    v_perm_b32 v76, v133, v129, s51
    v_perm_b32 v80, v134, v130, s50
    v_perm_b32 v84, v134, v130, s51
    v_perm_b32 v88, v135, v131, s50
    v_perm_b32 v92, v135, v131, s51
    s_waitcnt vmcnt(4)
    v_perm_b32 v65, v140, v136, s50
    v_perm_b32 v69, v140, v136, s51
    v_perm_b32 v73, v141, v137, s50
    v_perm_b32 v77, v141, v137, s51
    v_perm_b32 v81, v142, v138, s50
    v_perm_b32 v85, v142, v138, s51
    v_perm_b32 v89, v143, v139, s50
    v_perm_b32 v93, v143, v139, s51
    s_waitcnt vmcnt(2)
    v_perm_b32 v66, v148, v144, s50
    v_perm_b32 v70, v148, v144, s51
    v_perm_b32 v74, v149, v145, s50
    v_perm_b32 v78, v149, v145, s51
    v_perm_b32 v82, v150, v146, s50
    v_perm_b32 v86, v150, v146, s51
    v_perm_b32 v90, v151, v147, s50
    v_perm_b32 v94, v151, v147, s51
    s_waitcnt vmcnt(0)
    v_perm_b32 v67, v156, v152, s50
    v_perm_b32 v71, v156, v152, s51
    v_perm_b32 v75, v157, v153, s50
    v_perm_b32 v79, v157, v153, s51
    v_perm_b32 v83, v158, v154, s50
    v_perm_b32 v87, v158, v154, s51
    v_perm_b32 v91, v159, v155, s50
    v_perm_b32 v95, v159, v155, s51
    v_mfma_f32_16x16x32_bf16 v[32:35], v[64:67], v[24:27], v[32:35]
    v_mfma_f32_16x16x32_bf16 v[36:39], v[68:71], v[24:27], v[36:39]
    v_mfma_f32_16x16x32_bf16 v[40:43], v[72:75], v[24:27], v[40:43]
    v_mfma_f32_16x16x32_bf16 v[44:47], v[76:79], v[24:27], v[44:47]
    v_mfma_f32_16x16x32_bf16 v[48:51], v[80:83], v[24:27], v[48:51]
    v_mfma_f32_16x16x32_bf16 v[52:55], v[84:87], v[24:27], v[52:55]
    v_mfma_f32_16x16x32_bf16 v[56:59], v[88:91], v[24:27], v[56:59]
    v_mfma_f32_16x16x32_bf16 v[60:63], v[92:95], v[24:27], v[60:63]
L_adone_57:
    s_mov_b64 exec, 3
    ds_write_b64 v230, v[4:5]
    s_mov_b32 exec_lo, 0x00030003
    s_mov_b32 exec_hi, 0x00030003
    ds_write_b128 v228, v[32:35] offset:0
    ds_write_b128 v228, v[36:39] offset:128
    ds_write_b128 v228, v[40:43] offset:256
    ds_write_b128 v228, v[44:47] offset:384
    ds_write_b128 v228, v[48:51] offset:512
    ds_write_b128 v228, v[52:55] offset:640
    ds_write_b128 v228, v[56:59] offset:768
    ds_write_b128 v228, v[60:63] offset:896
    s_mov_b64 exec, 1
    ds_add_rtn_u32 v238, v236, v237
    s_mov_b64 exec, -1
    s_waitcnt lgkmcnt(0)
    v_readfirstlane_b32 s55, v238
    s_cmp_lg_u32 s55, 3
    s_nop 2
    s_cbranch_scc1 L_nocomb_64
    ds_read_b64 v[16:17], v231 offset:0
    ds_read_b64 v[18:19], v231 offset:16
    ds_read_b64 v[20:21], v231 offset:32
    ds_read_b64 v[22:23], v231 offset:48
    ds_read_b128 v[32:35], v233 offset:0
    ds_read_b128 v[36:39], v233 offset:128
    ds_read_b128 v[40:43], v233 offset:1024
    ds_read_b128 v[44:47], v233 offset:1152
    ds_read_b128 v[48:51], v233 offset:2048
    ds_read_b128 v[52:55], v233 offset:2176
    ds_read_b128 v[56:59], v233 offset:3072
    ds_read_b128 v[60:63], v233 offset:3200
    s_waitcnt lgkmcnt(8)
    v_max3_f32 v24, v16, v18, v20
    v_max_f32 v24, v24, v22
    v_sub_f32 v16, v16, v24
    v_sub_f32 v18, v18, v24
    v_sub_f32 v20, v20, v24
    v_sub_f32 v22, v22, v24
    v_exp_f32 v16, v16
    v_exp_f32 v18, v18
    v_exp_f32 v20, v20
    v_exp_f32 v22, v22
    v_mul_f32 v25, v16, v17
    v_fmac_f32 v25, v18, v19
    v_fmac_f32 v25, v20, v21
    v_fmac_f32 v25, v22, v23
    s_waitcnt lgkmcnt(6)
    v_mul_f32 v64, v16, v32
    v_mul_f32 v65, v16, v33
    v_mul_f32 v66, v16, v34
    v_mul_f32 v67, v16, v35
    v_mul_f32 v68, v16, v36
    v_mul_f32 v69, v16, v37
    v_mul_f32 v70, v16, v38
    v_mul_f32 v71, v16, v39
    s_waitcnt lgkmcnt(4)
    v_fmac_f32 v64, v18, v40
    v_fmac_f32 v65, v18, v41
    v_fmac_f32 v66, v18, v42
    v_fmac_f32 v67, v18, v43
    v_fmac_f32 v68, v18, v44
    v_fmac_f32 v69, v18, v45
    v_fmac_f32 v70, v18, v46
    v_fmac_f32 v71, v18, v47
    s_waitcnt lgkmcnt(2)
    v_fmac_f32 v64, v20, v48
    v_fmac_f32 v65, v20, v49
    v_fmac_f32 v66, v20, v50
    v_fmac_f32 v67, v20, v51
    v_fmac_f32 v68, v20, v52
    v_fmac_f32 v69, v20, v53
    v_fmac_f32 v70, v20, v54
    v_fmac_f32 v71, v20, v55
    s_waitcnt lgkmcnt(0)
    v_fmac_f32 v64, v22, v56
    v_fmac_f32 v65, v22, v57
    v_fmac_f32 v66, v22, v58
    v_fmac_f32 v67, v22, v59
    v_fmac_f32 v68, v22, v60
    v_fmac_f32 v69, v22, v61
    v_fmac_f32 v70, v22, v62
    v_fmac_f32 v71, v22, v63
    v_cvt_pk_bf16_f32 v72, v64, v65
    v_cvt_pk_bf16_f32 v73, v66, v67
    v_cvt_pk_bf16_f32 v74, v68, v69
    v_cvt_pk_bf16_f32 v75, v70, v71
    v_mov_b32_dpp v72, v24 quad_perm:[0,0,0,0] row_mask:0xc bank_mask:0xf
    v_mov_b32_dpp v73, v25 quad_perm:[0,0,0,0] row_mask:0xc bank_mask:0xf
    v_mov_b32_dpp v74, v24 quad_perm:[1,1,1,1] row_mask:0xc bank_mask:0xf
    v_mov_b32_dpp v75, v25 quad_perm:[1,1,1,1] row_mask:0xc bank_mask:0xf
    v_min_u32 v72, -2, v72
    v_min_u32 v73, -2, v73
    v_min_u32 v74, -2, v74
    v_min_u32 v75, -2, v75
    s_mov_b32 exec_hi, 0xff
    buffer_store_dwordx4 v[72:75], v234, s[4:7], s54 offen sc1
    s_mov_b64 exec, -1
    s_branch L_fin
L_nocomb_64:
    s_cmp_lg_u32 s55, 0
    s_cbranch_scc1 L_fin
    s_mov_b32 s12, s86
    s_mov_b32 s13, s87
    s_mov_b32 s14, 9216
    s_mov_b32 s15, 0x20000
    s_cmp_ge_u32 s2, 72
    s_cbranch_scc1 L_fin
    s_cmp_ge_u32 s2, 36
    s_cselect_b32 s56, 36, 0
    s_cselect_b32 s57, 294912, 0
    s_cselect_b32 s60, 1152, 0
    s_movk_i32 s61, 224
    s_cselect_b32 s61, 192, s61
    s_sub_u32 s56, s2, s56
    s_add_u32 s57, s57, 589824
    s_mul_i32 s58, s56, 7282
    s_lshr_b32 s58, s58, 16
    s_mul_i32 s59, s58, 9
    s_sub_u32 s59, s56, s59
    s_mul_i32 s62, s58, 2304
    s_add_u32 s60, s60, s62
    s_lshl_b32 s62, s59, 7
    s_add_u32 s60, s60, s62
    s_lshl_b32 s62, s59, 10
    s_add_u32 s57, s57, s62
    v_lshrrev_b32 v1, 4, v0
    v_and_b32 v2, 15, v0
    v_mul_u32_u24 v3, 9216, v1
    v_and_b32 v6, 31, v0
    v_add_u32 v6, s61, v6
    s_cmp_eq_u32 s59, 8
    s_cbranch_scc1 L_rt2_65
    s_lshl_b32 s62, s58, 8
    v_lshl_add_u32 v3, v2, 4, v3
    v_lshlrev_b32 v5, 1, v0
    s_nop 0
    s_branch L_rtj_66
L_rt2_65:
    s_lshl_b32 s62, s58, 6
    v_lshrrev_b32 v4, 2, v2
    v_lshl_add_u32 v3, v4, 8, v3
    v_and_b32 v4, 3, v2
    v_lshl_add_u32 v3, v4, 4, v3
    v_lshl_add_u32 v5, v2, 2, v1
    v_lshlrev_b32 v5, 1, v5
L_rtj_66:
    s_add_u32 s57, s57, s62
    s_add_u32 s16, s57, 0
    s_add_u32 s17, s57, 36864
    s_add_u32 s18, s57, 73728
    s_add_u32 s19, s57, 110592
    s_add_u32 s20, s57, 147456
    s_add_u32 s21, s57, 184320
    s_add_u32 s22, s57, 221184
    s_add_u32 s23, s57, 258048
    v_lshlrev_b32 v6, 7, v6
    v_add_u32 v6, 32768, v6
    s_mov_b32 s29, 200000
L_cf_67:
    buffer_load_dword v45, v6, s[4:7], 0 offen sc1
    s_sub_u32 s29, s29, 1
    s_cbranch_scc1 L_cf_67_x
    s_waitcnt vmcnt(0)
    v_cmp_ne_u32 vcc, s63, v45
    s_nop 3
    s_cbranch_vccz L_cf_67_x
    s_mov_b64 exec, vcc
    s_sleep 4
    s_branch L_cf_67
L_cf_67_x:
    s_mov_b64 exec, -1
    s_waitcnt vmcnt(0)
    s_mov_b32 s29, 200000
    buffer_load_dwordx4 v[8:11], v3, s[4:7], s16 offen sc1
    buffer_load_dwordx4 v[12:15], v3, s[4:7], s17 offen sc1
    buffer_load_dwordx4 v[16:19], v3, s[4:7], s18 offen sc1
    buffer_load_dwordx4 v[20:23], v3, s[4:7], s19 offen sc1
    buffer_load_dwordx4 v[24:27], v3, s[4:7], s20 offen sc1
    buffer_load_dwordx4 v[28:31], v3, s[4:7], s21 offen sc1
    buffer_load_dwordx4 v[32:35], v3, s[4:7], s22 offen sc1
    buffer_load_dwordx4 v[36:39], v3, s[4:7], s23 offen sc1
L_fp_68:
    buffer_load_dwordx4 v[8:11], v3, s[4:7], s16 offen sc1
    buffer_load_dwordx4 v[12:15], v3, s[4:7], s17 offen sc1
    buffer_load_dwordx4 v[16:19], v3, s[4:7], s18 offen sc1
    buffer_load_dwordx4 v[20:23], v3, s[4:7], s19 offen sc1
    buffer_load_dwordx4 v[24:27], v3, s[4:7], s20 offen sc1
    buffer_load_dwordx4 v[28:31], v3, s[4:7], s21 offen sc1
    buffer_load_dwordx4 v[32:35], v3, s[4:7], s22 offen sc1
    buffer_load_dwordx4 v[36:39], v3, s[4:7], s23 offen sc1
    s_sub_u32 s29, s29, 1
    s_cbranch_scc1 L_fp_68_x
    s_waitcnt vmcnt(8)
    v_max3_u32 v44, v8, v9, v10
    v_max3_u32 v44, v44, v11, v12
    v_max3_u32 v44, v44, v13, v14
    v_max3_u32 v44, v44, v15, v16
    v_max3_u32 v44, v44, v17, v18
    v_max3_u32 v44, v44, v19, v20
    v_max3_u32 v44, v44, v21, v22
    v_max3_u32 v44, v44, v23, v24
    v_max3_u32 v44, v44, v25, v26
    v_max3_u32 v44, v44, v27, v28
    v_max3_u32 v44, v44, v29, v30
    v_max3_u32 v44, v44, v31, v32
    v_max3_u32 v44, v44, v33, v34
    v_max3_u32 v44, v44, v35, v36
    v_max3_u32 v44, v44, v37, v38
    v_max_u32 v44, v44, v39
    v_cmp_eq_u32 vcc, -1, v44
    s_nop 3
    s_cbranch_vccz L_fp_68_x
    s_mov_b64 exec, vcc
    s_sleep 1
    s_branch L_fp_68
L_fp_68_x:
    s_mov_b64 exec, -1
    v_add_f32 v48, v8, v24
    v_add_f32 v49, v9, v25
    v_add_f32 v50, v10, v26
    v_add_f32 v51, v11, v27
    v_add_f32 v52, v12, v28
    v_add_f32 v53, v13, v29
    v_add_f32 v54, v14, v30
    v_add_f32 v55, v15, v31
    v_add_f32 v56, v16, v32
    v_add_f32 v57, v17, v33
    v_add_f32 v58, v18, v34
    v_add_f32 v59, v19, v35
    v_add_f32 v60, v20, v36
    v_add_f32 v61, v21, v37
    v_add_f32 v62, v22, v38
    v_add_f32 v63, v23, v39
    v_add_f32 v48, v48, v56
    v_add_f32 v49, v49, v57
    v_add_f32 v50, v50, v58
    v_add_f32 v51, v51, v59
    v_add_f32 v52, v52, v60
    v_add_f32 v53, v53, v61
    v_add_f32 v54, v54, v62
    v_add_f32 v55, v55, v63
    v_add_f32 v48, v48, v52
    v_add_f32 v49, v49, v53
    v_add_f32 v50, v50, v54
    v_add_f32 v51, v51, v55
    s_nop 0
    v_permlane32_swap_b32 v48, v50
    v_permlane32_swap_b32 v49, v51
    v_add_f32 v48, v48, v50
    v_add_f32 v49, v49, v51
    s_nop 1
    v_permlane16_swap_b32 v48, v49
    v_add_f32 v48, v48, v49
    v_cvt_pk_bf16_f32 v48, v48, v48
    buffer_store_short v48, v5, s[12:15], s60 offen
    s_cmp_lg_u32 s2, 0
    s_cbranch_scc1 L_fin
    v_mov_b32 v52, s63
    v_mov_b32 v53, 0
    s_mov_b64 exec, 1
    buffer_store_dword v52, v53, s[4:7], 0 offen sc1
    s_mov_b64 exec, -1
L_fin:
L_end:
    s_endpgm
.section .rodata,"a"
.p2align 6
.amdhsa_kernel concat_heads__gqa_block_cached__compressed_kv_cla__decode_kernel
  .amdhsa_next_free_vgpr 256
  .amdhsa_next_free_sgpr 102
  .amdhsa_accum_offset 256
  .amdhsa_group_segment_fixed_size 0
  .amdhsa_kernarg_size 112
  .amdhsa_user_sgpr_count 2
  .amdhsa_user_sgpr_kernarg_segment_ptr 1
  .amdhsa_system_sgpr_workgroup_id_x 1
.end_amdhsa_kernel
```
